```python
import torch

def _softmax(x, axis=-1):
    return torch.softmax(x, dim=axis)
def _gelu(x):
    return torch.nn.functional.gelu(x, approximate="tanh")
def _silu(x):
    return torch.nn.functional.silu(x)
def _sigmoid(x):
    return torch.sigmoid(x)
def _layernorm(x, axis=-1, eps=1e-5):
    m = x.mean(dim=axis, keepdim=True)
    v = x.var(dim=axis, keepdim=True, unbiased=False)
    return (x - m) / torch.sqrt(v + eps)
def _scatter_add(tgt, idx, src, axis=0):
    return tgt.clone().index_add_(axis, idx, src)
def _segment_sum(src, seg, n):
    out = torch.zeros((n,) + src.shape[1:], dtype=src.dtype)
    return out.index_add_(0, seg, src)
def _pad(x, pw):
    flat = tuple(v for pair in reversed(pw) for v in pair)
    return torch.nn.functional.pad(x, flat)

kernel_name = 'interleave_layers__sliding_block_cached__dense_activation_mish__decode'

def setup_inputs():

    _w = (lambda a: (lambda t: t.to(torch.bfloat16) if t.is_floating_point() else t)(torch.as_tensor(a)))
    def _A_setup():
        B, Sq, D = 1, 1, 640
        Hq, Hkv, Sk, Dh = 32, 32, 8192, 192
        assert Hq % Hkv == 0, (Hq, Hkv)
        return {
            "x": _w((lambda *s: torch.randn(*s, dtype=torch.bfloat16) * 0.1)(B, Sq, D)),
            "k_cache": _w((lambda *s: torch.randn(*s, dtype=torch.bfloat16) * 0.8)(B, Hkv, Sk, Dh)),
            "v_cache": _w((lambda *s: torch.randn(*s, dtype=torch.bfloat16) * 3.2)(B, Hkv, Sk, Dh)),
            "wq": _w((lambda *s: torch.randn(*s, dtype=torch.bfloat16) * 0.8)(D, Hq * Dh) * (D ** -0.5)),
            "wo": _w((lambda *s: torch.randn(*s, dtype=torch.bfloat16) * 3.2)(Hq * Dh, D) * ((Hq * Dh) ** -0.5)),
        }
    _A_in = _A_setup()

    def _B_setup():
        B, S, D, F = 1, 1, 640, 1536
        return {
            "x": _w((lambda *s: torch.randn(*s, dtype=torch.bfloat16) * 0.1)(B, S, D)),
            "w1": _w((lambda *s: torch.randn(*s, dtype=torch.bfloat16) * 1.6)(D, F) * (D ** -0.5)),
            "b1": _w((lambda *s: torch.randn(*s, dtype=torch.bfloat16) * 0.4)(F)),
            "w2": _w((lambda *s: torch.randn(*s, dtype=torch.bfloat16) * 0.4)(F, D) * (F ** -0.5)),
        }
    _B_in = _B_setup()

    return {
        "A_x": _A_in["x"],
        "A_k_cache": _A_in["k_cache"],
        "A_v_cache": _A_in["v_cache"],
        "A_wq": _A_in["wq"],
        "A_wo": _A_in["wo"],
        "B_x": _B_in["x"],
        "B_w1": _B_in["w1"],
        "B_b1": _B_in["b1"],
        "B_w2": _B_in["w2"],
    }

def reference(A_x, A_k_cache, A_v_cache, A_wq, A_wo, B_x, B_w1, B_b1, B_w2):
    def _A_ref(x, k_cache, v_cache, wq, wo):
        B, Sq, D = x.shape
        Hq, Dh = 32, 192
        Hkv, Sk = k_cache.shape[1], k_cache.shape[2]
        W = min(4096, max(256, Sk // 4))
        rep = Hq // Hkv
        q = (lambda x, *d: x.permute(*d))((x @ wq).reshape(B, Sq, Hq, Dh), 0, 2, 1, 3)
        k = (lambda x, n, axis: torch.repeat_interleave(x, n, dim=axis))(k_cache[:, :, Sk - W:, :], rep, axis=1)
        v = (lambda x, n, axis: torch.repeat_interleave(x, n, dim=axis))(v_cache[:, :, Sk - W:, :], rep, axis=1)
        scores = torch.einsum("bhqd,bhkd->bhqk", q, k) * (Dh ** -0.5)
        p = _softmax(scores, axis=-1)
        o = torch.einsum("bhqk,bhkd->bhqd", p, v)
        return (lambda x, *d: x.permute(*d))(o, 0, 2, 1, 3).reshape(B, Sq, Hq * Dh) @ wo

    def _B_ref(x, w1, b1, w2):
        h = torch.einsum("bsd,df->bsf", x, w1) + b1
        sp = torch.log1p(torch.exp(-torch.abs(h))) + torch.where(h > 0, h, torch.zeros_like(h))
        act = h * torch.tanh(sp)
        return torch.einsum("bsf,fd->bsd", act, w2)

    x = A_x
    x = x + _A_ref(_layernorm(x, axis=-1), A_k_cache, A_v_cache, A_wq, A_wo)
    x = x + _B_ref(_layernorm(x, axis=-1), B_w1, B_b1, B_w2)
    x = x + _A_ref(_layernorm(x, axis=-1), A_k_cache, A_v_cache, A_wq, A_wo)
    x = x + _B_ref(_layernorm(x, axis=-1), B_w1, B_b1, B_w2)
    return x
```

```asm
; @launch grid=(256,1,1) block=(1024,1,1) lds=48640
.amdgcn_target "amdgcn-amd-amdhsa--gfx950"
.text
.globl interleave_layers__sliding_block_cached__dense_activation_mish__decode_kernel
.p2align 8
.type interleave_layers__sliding_block_cached__dense_activation_mish__decode_kernel,@function
interleave_layers__sliding_block_cached__dense_activation_mish__decode_kernel:
    s_cmp_ge_u32 s2, 256
    s_cbranch_scc1 L_exit
    s_load_dwordx16 s[4:19], s[0:1], 0
    s_load_dwordx8 s[20:27], s[0:1], 64
    v_lshrrev_b32 v5, 6, v0
    v_and_b32 v0, 63, v0
    v_readfirstlane_b32 s32, v5
    s_and_b32 s28, s2, 7
    s_lshr_b32 s29, s2, 3
    s_lshr_b32 s46, s29, 3
    s_lshl_b32 s30, s28, 2
    s_add_u32 s30, s30, s46
    s_and_b32 s31, s29, 7
    s_cmp_ge_u32 s32, 8
    s_cbranch_scc1 L_kv
    s_setprio 3
    v_and_b32 v5, 7, v0
    v_bfe_u32 v6, v0, 3, 1
    v_bfe_u32 v7, v0, 4, 1
    v_lshl_add_u32 v6, v7, 3, v6
    v_bfe_u32 v7, v0, 5, 1
    v_lshl_add_u32 v6, v7, 1, v6
    s_mul_i32 s47, s31, 160
    v_min_u32 v8, 39, v0
    v_lshl_add_u32 v8, v8, 2, s47
    s_mul_i32 s46, s31, 983040
    s_mul_i32 s47, s30, 384
    s_add_u32 s46, s46, s47
    s_sub_u32 s47, s32, 5
    s_lshl_b32 s47, s47, 7
    s_add_u32 s46, s46, s47
    v_mul_u32_u24 v7, 12288, v6
    v_lshl_add_u32 v7, v5, 4, v7
    v_add_u32 v7, s46, v7
    v_lshlrev_b32 v9, 2, v0
    s_waitcnt lgkmcnt(0)
    s_cmp_lt_u32 s32, 5
    s_cbranch_scc1 L_w_issued
    global_load_dword v12, v8, s[4:5]
    global_load_dword v22, v9, s[4:5] offset:0
    global_load_dword v23, v9, s[4:5] offset:256
    global_load_dword v24, v9, s[4:5] offset:512
    global_load_dword v25, v9, s[4:5] offset:768
    global_load_dword v26, v9, s[4:5] offset:1024
    global_load_dwordx4 v[80:83], v7, s[10:11] nt
    v_add_u32 v7, 49152, v7
    global_load_dwordx4 v[84:87], v7, s[10:11] nt
    v_add_u32 v7, 147456, v7
    global_load_dwordx4 v[88:91], v7, s[10:11] nt
    v_add_u32 v7, 49152, v7
    global_load_dwordx4 v[92:95], v7, s[10:11] nt
    v_add_u32 v7, 147456, v7
    global_load_dwordx4 v[96:99], v7, s[10:11] nt
    v_add_u32 v7, 49152, v7
    global_load_dwordx4 v[100:103], v7, s[10:11] nt
    v_add_u32 v7, 147456, v7
    global_load_dwordx4 v[104:107], v7, s[10:11] nt
    v_add_u32 v7, 49152, v7
    global_load_dwordx4 v[108:111], v7, s[10:11] nt
    v_add_u32 v7, 147456, v7
    global_load_dwordx4 v[112:115], v7, s[10:11] nt
    v_add_u32 v7, 49152, v7
    global_load_dwordx4 v[116:119], v7, s[10:11] nt
    s_nop 0
L_w_issued:
    s_barrier
    s_add_u32 s26, s26, 0x1fffff
    s_addc_u32 s27, s27, 0
    s_and_b32 s26, s26, 0xffe00000
    s_add_u32 s46, s26, 0x1e0004
    s_addc_u32 s47, s27, 0
    s_load_dword s34, s[46:47], 0
    s_mov_b64 s[40:41], s[26:27]
    s_mov_b32 s50, 0xffffff00
    s_mov_b32 s57, 0xffff0000
    s_mov_b32 s52, 0x00ff00ff
    s_mov_b32 s53, 0xff00ff00
    s_mov_b32 s54, 0x00ff00ff
    s_mov_b32 s55, 0x00ff00ff
    s_mov_b32 s39, 0
    s_mov_b32 s42, 0
    s_mov_b32 s3, 0
    s_mov_b32 s43, 13824
    s_cmp_ge_u32 s29, 10
    s_cselect_b32 s36, 1, 0
    s_mul_i32 s48, s36, 10
    s_sub_u32 s37, s29, s48
    s_mov_b32 s35, 0
    s_cmp_lt_u32 s29, 20
    s_cbranch_scc1 L_roledone_1
    s_cmp_ge_u32 s29, 26
    s_cselect_b32 s35, 2, 1
    s_cselect_b32 s48, 26, 20
    s_sub_u32 s48, s29, s48
    s_and_b32 s37, s48, 1
    s_lshr_b32 s48, s48, 1
    s_mul_i32 s36, s28, 3
    s_add_u32 s36, s36, s48
L_roledone_1:
    v_and_b32 v4, 3, v0
    s_mov_b32 s48, 0x55555555
    v_mul_lo_u32 v1, v4, s48
    v_and_b32 v4, 4, v0
    v_cmp_eq_u32 vcc, 0, v4
    v_mov_b32 v4, 0xffff
    s_nop 0
    v_cndmask_b32 v2, 0, v4, vcc
    v_cndmask_b32 v3, v4, 0, vcc
    s_add_u32 s56, s32, 4
    s_cmp_ge_u32 s56, 6
    s_cselect_b32 s46, 1, 0
    s_mul_i32 s47, s46, 6
    s_sub_u32 s47, s56, s47
    s_lshl_b32 s48, s28, 2
    s_and_b32 s49, s36, 1
    s_lshl_b32 s49, s49, 1
    s_add_u32 s48, s48, s49
    s_add_u32 s48, s48, s46
    s_mul_i32 s44, s48, 7168
    s_lshl_b32 s49, s47, 7
    s_add_u32 s44, s44, s49
    s_add_u32 s44, s44, 0x38000
    s_lshl_b32 s45, s48, 7
    s_add_u32 s45, s45, 0x70000
    s_mul_i32 s51, s46, 192
    s_lshl_b32 s49, s47, 5
    s_add_u32 s51, s51, s49
    s_mul_i32 s46, s32, 800
    v_min_u32 v9, 49, v0
    v_lshl_add_u32 v9, v9, 4, s46
    v_mov_b32 v16, 0
    v_mov_b32 v17, 0
    v_mov_b32 v18, 0
    v_mov_b32 v19, 0
    ds_write_b128 v9, v[16:19] offset:6400
    v_and_b32 v9, 15, v0
    v_lshlrev_b32 v9, 11, v9
    v_mov_b32 v10, -1
    ds_write_b32 v9, v10 offset:15616
    v_and_b32 v5, 7, v0
    v_lshrrev_b32 v6, 3, v0
    v_lshrrev_b32 v7, 2, v5
    v_mul_u32_u24 v7, 3200, v7
    v_mul_u32_u24 v8, 400, v6
    v_add_u32 v122, v7, v8
    v_bfe_u32 v7, v0, 4, 1
    v_lshlrev_b32 v7, 4, v7
    v_lshl_add_u32 v7, v5, 5, v7
    v_lshrrev_b32 v8, 5, v0
    v_lshl_add_u32 v126, v8, 3, v7
    v_mov_b32 v123, 0
    v_mov_b32 v121, 0x1d0000
    v_mov_b32 v120, 0x1d0000
    v_mov_b32 v127, 0
    v_mov_b32 v124, 0
    v_mov_b32 v125, 0
    s_cmp_lt_u32 s32, 5
    s_cbranch_scc1 L_w_x0ok
    v_mul_u32_u24 v8, 400, v6
    v_lshl_add_u32 v8, v5, 3, v8
    v_mov_b32 v9, 0
    ds_write_b32 v8, v9 offset:80
    v_min_u32 v8, 39, v0
    v_and_b32 v9, 3, v8
    v_mul_u32_u24 v9, 800, v9
    v_lshrrev_b32 v8, 2, v8
    v_lshl_add_u32 v8, v8, 3, v9
    v_mov_b32 v15, 0
    v_mov_b32 v17, 0
    v_mov_b32 v18, 0
    v_mov_b32 v20, 0
    v_mov_b32 v28, 0
    v_mov_b32 v29, 0
    v_mov_b32 v9, 0x3f803f80
    s_waitcnt vmcnt(10)
    v_dot2c_f32_bf16 v28, v22, v9
    v_dot2c_f32_bf16 v29, v22, v22
    v_dot2c_f32_bf16 v28, v23, v9
    v_dot2c_f32_bf16 v29, v23, v23
    v_dot2c_f32_bf16 v28, v24, v9
    v_dot2c_f32_bf16 v29, v24, v24
    v_dot2c_f32_bf16 v28, v25, v9
    v_dot2c_f32_bf16 v29, v25, v25
    v_dot2c_f32_bf16 v28, v26, v9
    v_dot2c_f32_bf16 v29, v26, v26
    s_nop 1
    v_add_f32_dpp v28, v28, v28 quad_perm:[1,0,3,2] row_mask:0xf bank_mask:0xf
    v_add_f32_dpp v29, v29, v29 quad_perm:[1,0,3,2] row_mask:0xf bank_mask:0xf
    s_nop 0
    v_add_f32_dpp v28, v28, v28 quad_perm:[2,3,0,1] row_mask:0xf bank_mask:0xf
    v_add_f32_dpp v29, v29, v29 quad_perm:[2,3,0,1] row_mask:0xf bank_mask:0xf
    s_nop 0
    v_add_f32_dpp v28, v28, v28 row_half_mirror row_mask:0xf bank_mask:0xf
    v_add_f32_dpp v29, v29, v29 row_half_mirror row_mask:0xf bank_mask:0xf
    s_nop 0
    v_add_f32_dpp v28, v28, v28 row_ror:8 row_mask:0xf bank_mask:0xf
    v_add_f32_dpp v29, v29, v29 row_ror:8 row_mask:0xf bank_mask:0xf
    s_nop 0
    v_add_f32_dpp v28, v28, v28 row_bcast:15 row_mask:0xa bank_mask:0xf
    v_add_f32_dpp v29, v29, v29 row_bcast:15 row_mask:0xa bank_mask:0xf
    s_nop 0
    v_add_f32_dpp v28, v28, v28 row_bcast:31 row_mask:0xc bank_mask:0xf
    v_add_f32_dpp v29, v29, v29 row_bcast:31 row_mask:0xc bank_mask:0xf
    v_mul_f32 v28, 0x3acccccd, v28
    v_mul_f32 v29, 0x3acccccd, v29
    v_fma_f32 v29, -v28, v28, v29
    v_max_f32 v29, 0, v29
    v_add_f32 v29, 0x3727c5ac, v29
    v_rsq_f32 v29, v29
    v_readlane_b32 s46, v28, 63
    v_readlane_b32 s47, v29, 63
    v_lshlrev_b32 v14, 16, v12
    v_and_b32 v16, s57, v12
    v_subrev_f32 v14, s46, v14
    v_subrev_f32 v16, s46, v16
    v_mul_f32 v14, s47, v14
    v_mul_f32 v16, s47, v16
    v_cvt_pk_bf16_f32 v12, v14, v16
    v_and_b32 v14, 0xffff, v12
    v_lshrrev_b32 v16, 16, v12
    v_and_b32 v19, 0xffff, v12
    v_lshrrev_b32 v21, 16, v12
    ds_write_b64 v8, v[14:15] offset:0
    ds_write_b64 v8, v[16:17] offset:400
    ds_write_b64 v8, v[18:19] offset:3200
    ds_write_b64 v8, v[20:21] offset:3600
L_w_x0ok:
    s_waitcnt lgkmcnt(0)
    s_mul_i32 s34, s34, 0x9e3779b1
    s_add_u32 s34, s34, 0x7f4a7c15
    s_and_b32 s33, s34, 0xff
    s_cmp_lg_u32 s32, 4
    s_cbranch_scc1 L_w_pre
    s_getreg_b32 s46, hwreg(HW_REG_XCC_ID)
    s_lshl_b32 s47, s28, 8
    s_lshl_b32 s48, s29, 3
    s_add_u32 s47, s47, s48
    s_add_u32 s47, s47, 0x1d8000
    v_mov_b32 v5, s47
    s_and_b32 s46, s46, 15
    v_mov_b32 v6, s46
    v_mov_b32 v7, s34
    s_mov_b64 exec, 1
    global_store_dwordx2 v5, v[6:7], s[26:27] sc1
    s_mov_b64 exec, -1
    s_mov_b32 s49, 0
    s_and_b32 s46, s2, 63
    s_lshl_b32 s46, s46, 7
    s_lshr_b32 s47, s2, 6
    s_lshl_b32 s47, s47, 14
    s_add_u32 s46, s46, s47
    s_add_u32 s46, s46, 0x1f0000
    s_add_u32 s46, s46, s26
    s_addc_u32 s47, s27, 0
    s_mov_b32 s58, -1
    s_mov_b32 s59, -1
    s_mov_b32 s38, 3
L_w_np:
    s_memtime s[60:61]
    s_waitcnt lgkmcnt(0)
    s_load_dword s48, s[46:47], 0x0 glc
    s_waitcnt lgkmcnt(0)
    s_memtime s[62:63]
    s_waitcnt lgkmcnt(0)
    s_sub_u32 s62, s62, s60
    s_min_u32 s58, s58, s62
    s_memtime s[60:61]
    s_waitcnt lgkmcnt(0)
    s_load_dword s48, s[46:47], 0x2000 glc
    s_waitcnt lgkmcnt(0)
    s_memtime s[62:63]
    s_waitcnt lgkmcnt(0)
    s_sub_u32 s62, s62, s60
    s_min_u32 s59, s59, s62
    s_sub_u32 s38, s38, 1
    s_cmp_lg_u32 s38, 0
    s_cbranch_scc1 L_w_np
    s_cmp_lt_u32 s59, s58
    s_cselect_b32 s49, 0x2000, 0
    v_mov_b32 v6, s49
    s_mov_b64 exec, 1
    global_store_dwordx2 v5, v[6:7], s[26:27] offset:2048 sc1
    s_mov_b64 exec, -1
L_w_pre:
    s_cmp_lt_u32 s32, 5
    s_cbranch_scc1 L_w_noq
    v_mov_b32 v5, s33
    s_lshl_b32 s46, s30, 3
    s_add_u32 s46, s46, s31
    s_mul_i32 s46, s46, 896
    s_sub_u32 s47, s32, 5
    s_lshl_b32 s47, s47, 8
    s_add_u32 s46, s46, s47
    v_add_u32 v6, s46, v126
    v_mov_b32 v8, 0
    v_mov_b32 v9, 0
    v_mov_b32 v10, 0
    v_mov_b32 v11, 0
    s_waitcnt vmcnt(0)
    s_cmp_eq_u32 s39, 0
    s_cbranch_scc1 L_w_q_nb
    s_barrier
L_w_q_nb:
    ds_read_b128 v[32:35], v122 offset:0
    ds_read_b128 v[36:39], v122 offset:16
    ds_read_b128 v[40:43], v122 offset:32
    ds_read_b128 v[44:47], v122 offset:48
    ds_read_b128 v[48:51], v122 offset:64
    s_waitcnt lgkmcnt(4)
    v_smfmac_f32_16x16x64_bf16 v[8:11], v[32:35], v[80:87], v1
    s_waitcnt lgkmcnt(3)
    v_smfmac_f32_16x16x64_bf16 v[8:11], v[36:39], v[88:95], v1
    s_waitcnt lgkmcnt(2)
    v_smfmac_f32_16x16x64_bf16 v[8:11], v[40:43], v[96:103], v1
    s_waitcnt lgkmcnt(1)
    v_smfmac_f32_16x16x64_bf16 v[8:11], v[44:47], v[104:111], v1
    s_waitcnt lgkmcnt(0)
    v_smfmac_f32_16x16x64_bf16 v[8:11], v[48:51], v[112:119], v1
    s_nop 7
    v_permlane32_swap_b32 v8, v10
    v_permlane32_swap_b32 v9, v11
    s_nop 0
    v_add_f32_dpp v12, v10, v8 row_ror:8 row_mask:0xf bank_mask:0xf
    v_add_f32_dpp v13, v11, v9 row_ror:8 row_mask:0xf bank_mask:0xf
    v_and_or_b32 v13, v13, s50, v5
    s_mov_b64 exec, s[54:55]
    s_cmp_eq_u32 s42, 0
    s_cbranch_scc1 L_slow_2
    global_store_dwordx2 v6, v[12:13], s[40:41]
L_back_3:
    s_mov_b64 exec, -1
    s_cmp_lg_u32 s39, 0
    s_cbranch_scc1 L_w_qdone
    v_add_u32 v121, 0x188000, v6
    s_lshl_b32 s46, s32, 2
    s_add_u32 s46, s46, 13440
    v_mov_b32 v9, s46
    v_mov_b32 v10, s34
    s_waitcnt vmcnt(0)
    ds_write_b32 v9, v10
L_w_noq:
    v_mov_b32 v9, 13440
    s_nop 1
L_w_fspin:
    s_sleep 2
    ds_read_b128 v[12:15], v9 offset:16
    s_waitcnt lgkmcnt(0)
    v_bitop3_b32 v12, v12, v13, s34 bitop3:0x7e
    v_bitop3_b32 v14, v14, v15, s34 bitop3:0x7e
    v_or_b32 v12, v12, v14
    v_cmp_ne_u32 vcc, 0, v12
    s_nop 0
    s_cbranch_vccnz L_w_fspin
    s_cmp_lg_u32 s32, 6
    s_cbranch_scc1 L_w_qdone
    s_lshl_b32 s47, s28, 8
    s_add_u32 s47, s47, 0x1d8000
    v_and_b32 v5, 31, v0
    v_lshl_add_u32 v5, v5, 3, s47
    s_mov_b32 s38, 0
    s_nop 0
L_w_xc:
    global_load_dwordx2 v[6:7], v5, s[26:27] sc1
    s_waitcnt vmcnt(0)
    v_cmp_ne_u32 vcc, s34, v7
    s_nop 0
    s_cbranch_vccz L_w_xcd
    s_sleep 8
    s_add_u32 s38, s38, 1
    s_cmp_lt_u32 s38, 2097152
    s_cbranch_scc1 L_w_xc
    s_branch L_end
L_w_xcd:
    s_getreg_b32 s46, hwreg(HW_REG_XCC_ID)
    s_and_b32 s46, s46, 15
    v_and_b32 v7, 15, v6
    v_cmp_ne_u32 vcc, s46, v7
    s_nop 0
    s_cmp_eq_u64 vcc, 0
    s_cselect_b32 s46, 1, 0
    v_mov_b32 v10, s46
    ds_write_b32 v9, v10 offset:4
    s_waitcnt lgkmcnt(0)
L_w_qdone:
    s_cmp_ge_u32 s32, 6
    s_cbranch_scc1 L_w_h5done
    v_mov_b32 v5, s33
    v_and_b32 v24, 7, v0
    v_lshrrev_b32 v25, 3, v0
    s_mul_i32 s46, s30, 7168
    s_lshl_b32 s47, s32, 7
    s_add_u32 s47, s47, s46
    v_mul_u32_u24 v6, 896, v25
    v_lshl_add_u32 v6, v24, 4, v6
    v_add_u32 v6, s47, v6
    s_lshl_b32 s46, s30, 7
    s_add_u32 s46, s46, 466944
    v_lshl_add_u32 v7, v24, 4, s46
    v_lshrrev_b32 v25, 4, v0
    v_lshl_add_u32 v25, v24, 2, v25
    s_lshl_b32 s46, s32, 6
    s_add_u32 s46, s46, 12800
    v_lshl_add_u32 v9, v25, 1, s46
    s_cmp_lg_u32 s39, 0
    s_cbranch_scc1 L_w_h5k1
    v_add_u32 v120, 0x188000, v6
    s_mov_b32 s38, 0
    s_nop 0
L_poll_4:
    global_load_dwordx4 v[12:15], v6, s[40:41] sc1
    s_waitcnt vmcnt(0)
    v_xor_b32 v13, v5, v13
    v_xor_b32 v15, v5, v15
    v_or_b32 v24, v13, v15
    v_cmp_ne_u32_sdwa vcc, v24, 0 src0_sel:BYTE_0 src1_sel:DWORD
    s_nop 0
    s_cbranch_vccnz L_retry_6
    v_permlane32_swap_b32 v12, v14
    v_permlane32_swap_b32 v13, v15
    v_add_f32 v12, v12, v14
    v_add_f32 v13, v13, v15
    s_nop 1
    v_permlane16_swap_b32 v12, v13
    v_add_f32 v12, v12, v13
    s_nop 1
    v_add_f32_dpp v12, v12, v12 row_ror:8 row_mask:0xf bank_mask:0xf
    v_mul_f32 v28, 0x3dd53b95, v12
    s_nop 0
    s_branch L_w_h5w
L_w_h5k1:
    s_mov_b32 s38, 0
L_pp_7:
    global_load_dwordx4 v[16:19], v7, s[40:41] sc1
    global_load_dwordx4 v[12:15], v6, s[40:41] sc1
    s_waitcnt vmcnt(0)
    v_xor_b32 v13, v5, v13
    v_xor_b32 v15, v5, v15
    v_or_b32 v24, v13, v15
    v_bitop3_b32 v25, v17, v19, s34 bitop3:0x7e
    v_or_b32_sdwa v24, v24, v25 dst_sel:DWORD dst_unused:UNUSED_PAD src0_sel:BYTE_0 src1_sel:DWORD
    v_cmp_ne_u32 vcc, 0, v24
    s_nop 0
    s_cbranch_vccnz L_retry_10
    v_permlane32_swap_b32 v12, v14
    v_permlane32_swap_b32 v13, v15
    v_add_f32_dpp v30, v16, v16 quad_perm:[1,0,3,2] row_mask:0xf bank_mask:0xf
    v_add_f32_dpp v31, v18, v18 quad_perm:[1,0,3,2] row_mask:0xf bank_mask:0xf
    v_add_f32 v28, v12, v14
    v_add_f32 v29, v13, v15
    v_add_f32_dpp v30, v30, v30 quad_perm:[2,3,0,1] row_mask:0xf bank_mask:0xf
    v_add_f32_dpp v31, v31, v31 quad_perm:[2,3,0,1] row_mask:0xf bank_mask:0xf
    v_permlane16_swap_b32 v28, v29
    v_add_f32_dpp v30, v30, v30 row_half_mirror row_mask:0xf bank_mask:0xf
    v_add_f32_dpp v31, v31, v31 row_half_mirror row_mask:0xf bank_mask:0xf
    v_add_f32 v28, v28, v29
    v_mul_f32 v30, 0x3acccccd, v30
    v_mul_f32 v31, 0x3acccccd, v31
    v_add_f32_dpp v28, v28, v28 row_ror:8 row_mask:0xf bank_mask:0xf
    v_fma_f32 v31, -v30, v30, v31
    v_max_f32 v31, 0, v31
    v_add_f32 v31, 0x3727c5ac, v31
    v_rsq_f32 v31, v31
    v_fma_f32 v28, -v30, v123, v28
    v_mul_f32 v28, 0x3dd53b95, v28
    v_mul_f32 v28, v28, v31
    s_nop 1
L_w_h5w:
    v_cvt_pk_bf16_f32 v28, v28, v28
    ds_write_b16 v9, v28
    s_waitcnt lgkmcnt(0)
    s_or_b32 s46, s39, s35
    s_cmp_lg_u32 s46, 0
    s_cbranch_scc1 L_w_h5done
    s_cmp_ge_u32 s32, 4
    s_cbranch_scc1 L_w_h5done
    v_and_b32 v5, 7, v0
    v_bfe_u32 v6, v0, 3, 1
    v_bfe_u32 v7, v0, 4, 1
    v_lshl_add_u32 v6, v7, 3, v6
    v_bfe_u32 v7, v0, 5, 1
    v_lshl_add_u32 v6, v7, 1, v6
    s_mul_i32 s46, s28, 768
    s_mul_i32 s47, s36, 384
    s_add_u32 s46, s46, s47
    s_mul_i32 s47, s32, 96
    s_add_u32 s46, s46, s47
    s_mul_i32 s46, s46, 1280
    s_lshl_b32 s47, s37, 7
    s_add_u32 s46, s46, s47
    v_mul_u32_u24 v7, 1280, v6
    v_lshl_add_u32 v7, v5, 4, v7
    v_add_u32 v127, s46, v7
    global_load_dwordx4 v[32:35], v127, s[12:13] nt
    v_add_u32 v127, 5120, v127
    global_load_dwordx4 v[36:39], v127, s[12:13] nt
    v_add_u32 v127, 15360, v127
    s_nop 1
L_w_h5done:
    s_barrier
    s_cmp_eq_u32 s39, 0
    s_cbranch_scc1 L_w_l0x
    s_cmp_lg_u32 s30, 0
    s_cbranch_scc1 L_w_roleld_done
    s_cmp_ge_u32 s32, 5
    s_cbranch_scc1 L_w_roleld_done
    s_mov_b32 exec_lo, 0x000f000f
    s_mov_b32 exec_hi, 0x000f000f
    global_store_dword v121, v120, s[26:27] sc1
    s_mov_b64 exec, -1
    s_branch L_w_roleld_done
L_w_l0x:
    v_mov_b32 v5, 13444
    ds_read_b32 v5, v5
    s_waitcnt lgkmcnt(0)
    v_readfirstlane_b32 s42, v5
    s_cmp_lt_u32 s32, 5
    s_nop 2
    s_cbranch_scc1 L_w_nopf0
    v_mov_b32 v5, s33
    v_mov_b32 v8, 0
    v_mov_b32 v9, 0
    v_mov_b32 v10, 0
    v_mov_b32 v11, 0
    v_and_b32 v16, 0x3f80, v2
    v_and_b32 v17, 0x3f80, v3
    v_and_b32 v18, 0x3f80, v2
    v_and_b32 v19, 0x3f80, v3
    s_nop 1
    v_smfmac_f32_16x16x64_bf16 v[8:11], v[16:19], v[80:87], v1
    v_smfmac_f32_16x16x64_bf16 v[8:11], v[16:19], v[88:95], v1
    v_smfmac_f32_16x16x64_bf16 v[8:11], v[16:19], v[96:103], v1
    v_smfmac_f32_16x16x64_bf16 v[8:11], v[16:19], v[104:111], v1
    v_smfmac_f32_16x16x64_bf16 v[8:11], v[16:19], v[112:119], v1
    s_nop 7
    v_permlane32_swap_b32 v8, v10
    v_permlane32_swap_b32 v9, v11
    s_nop 0
    v_add_f32_dpp v12, v10, v8 row_ror:8 row_mask:0xf bank_mask:0xf
    v_add_f32_dpp v13, v11, v9 row_ror:8 row_mask:0xf bank_mask:0xf
    v_and_or_b32 v13, v13, s50, v5
    s_mov_b64 exec, s[54:55]
    s_cmp_eq_u32 s42, 0
    s_cbranch_scc1 L_slow_11
    global_store_dwordx2 v121, v[12:13], s[26:27]
L_back_12:
    s_mov_b64 exec, -1
    s_cmp_lg_u32 s32, 7
    s_cbranch_scc1 L_w_nopf0
    s_lshl_b32 s46, s30, 3
    s_add_u32 s46, s46, s31
    s_mul_i32 s46, s46, 896
    s_add_u32 s46, s46, 0x0
    v_min_u32 v5, 47, v0
    v_lshl_add_u32 v5, v5, 4, s46
    v_add_u32 v6, 0x38000, v5
    s_lshl_b32 s46, s30, 7
    s_add_u32 s46, s46, 0x70000
    s_lshl_b32 s47, s28, 7
    s_add_u32 s48, s47, 0x74000
    s_add_u32 s49, s47, 0x75000
    s_mul_i32 s47, s28, 6144
    s_add_u32 s47, s47, 0x78000
    v_min_u32 v7, 47, v0
    v_lshl_add_u32 v7, v7, 7, s47
    s_mul_i32 s47, s28, 384
    s_add_u32 s47, s47, 0x73000
    v_min_u32 v8, 2, v0
    v_lshl_add_u32 v8, v8, 7, s47
    v_writelane_b32 v8, s46, 3
    v_writelane_b32 v8, s48, 4
    v_writelane_b32 v8, s49, 5
    s_add_u32 s46, s46, 0x2000
    v_writelane_b32 v8, s46, 6
    global_load_dwordx4 v[68:71], v6, s[40:41] sc1
    global_load_dword v72, v7, s[40:41] sc1
    global_load_dword v73, v8, s[40:41] sc1
L_w_nopf0:
    v_and_b32 v5, 7, v0
    v_bfe_u32 v6, v0, 3, 1
    v_bfe_u32 v7, v0, 4, 1
    v_lshl_add_u32 v6, v7, 3, v6
    v_bfe_u32 v7, v0, 5, 1
    v_lshl_add_u32 v6, v7, 1, v6
    s_cmp_eq_u32 s35, 1
    s_cbranch_scc1 L_w_ld1
    s_cmp_eq_u32 s35, 2
    s_cbranch_scc1 L_w_ld2
    s_cmp_ge_u32 s32, 4
    s_cbranch_scc1 L_w_roleld_done
    global_load_dwordx4 v[40:43], v127, s[12:13] nt
    v_add_u32 v127, 5120, v127
    global_load_dwordx4 v[44:47], v127, s[12:13] nt
    v_add_u32 v127, 15360, v127
    global_load_dwordx4 v[48:51], v127, s[12:13] nt
    v_add_u32 v127, 5120, v127
    global_load_dwordx4 v[52:55], v127, s[12:13] nt
    v_add_u32 v127, 15360, v127
    global_load_dwordx4 v[56:59], v127, s[12:13] nt
    v_add_u32 v127, 5120, v127
    global_load_dwordx4 v[60:63], v127, s[12:13] nt
    v_add_u32 v127, 15360, v127
    global_load_dwordx4 v[64:67], v127, s[12:13] nt
    v_add_u32 v127, 5120, v127
    global_load_dwordx4 v[68:71], v127, s[12:13] nt
    v_add_u32 v127, 15360, v127
    global_load_dwordx4 v[72:75], v127, s[12:13] nt
    v_add_u32 v127, 5120, v127
    global_load_dwordx4 v[76:79], v127, s[12:13] nt
    s_branch L_w_roleld_done
L_w_ld1:
    s_branch L_w_roleld_done
L_w_ld2:
L_w_roleld_done:
    s_cmp_ge_u32 s32, 4
    s_cbranch_scc1 L_w_nocomb
    v_mov_b32 v5, s33
    s_lshl_b32 s46, s32, 8
    s_add_u32 s47, s46, s43
    v_lshl_add_u32 v6, v0, 2, s47
    s_lshl_b32 s47, s30, 3
    s_add_u32 s47, s47, s31
    s_mul_i32 s48, s47, 896
    s_add_u32 s48, s48, s46
    s_add_u32 s48, s48, 0x38000
    v_lshl_add_u32 v7, v0, 2, s48
    s_lshl_b32 s47, s47, 4
    s_add_u32 s47, s47, 0x70000
    v_mov_b32 v8, s47
    v_and_b32 v9, 7, v0
    v_lshl_add_u32 v9, v9, 11, s43
    s_setprio 0
    s_mov_b32 s38, 0
L_w_mspin:
    s_add_u32 s38, s38, 1
    s_cmp_gt_u32 s38, 8388608
    s_cbranch_scc1 L_end
    s_sleep 2
    ds_read_b32 v12, v9 offset:1792
    s_waitcnt lgkmcnt(0)
    v_cmp_eq_u32 vcc, -1, v12
    s_nop 0
    s_cbranch_vccnz L_w_mspin
    s_setprio 3
    v_max_f32_dpp v10, v12, v12 quad_perm:[1,0,3,2] row_mask:0xf bank_mask:0xf
    s_nop 1
    v_max_f32_dpp v10, v10, v10 quad_perm:[2,3,0,1] row_mask:0xf bank_mask:0xf
    s_nop 1
    v_max_f32_dpp v10, v10, v10 row_half_mirror row_mask:0xf bank_mask:0xf
    v_sub_f32 v12, v12, v10
    v_exp_f32 v12, v12
    s_cmp_eq_u32 s32, 3
    s_cbranch_scc1 L_w_ml
    v_readlane_b32 s88, v12, 0
    v_readlane_b32 s89, v12, 1
    v_readlane_b32 s90, v12, 2
    v_readlane_b32 s91, v12, 3
    v_readlane_b32 s92, v12, 4
    v_readlane_b32 s93, v12, 5
    v_readlane_b32 s94, v12, 6
    v_readlane_b32 s95, v12, 7
    s_barrier
    ds_read2st64_b32 v[96:97], v6 offset0:0 offset1:4
    ds_read2st64_b32 v[98:99], v6 offset0:8 offset1:12
    ds_read2st64_b32 v[100:101], v6 offset0:16 offset1:20
    ds_read2st64_b32 v[102:103], v6 offset0:24 offset1:28
    ds_read2st64_b32 v[104:105], v6 offset0:32 offset1:36
    ds_read2st64_b32 v[106:107], v6 offset0:40 offset1:44
    ds_read2st64_b32 v[108:109], v6 offset0:48 offset1:52
    ds_read2st64_b32 v[110:111], v6 offset0:56 offset1:60
    s_waitcnt lgkmcnt(7)
    v_add_f32 v96, v96, v97
    v_mul_f32 v11, s88, v96
    s_waitcnt lgkmcnt(6)
    v_add_f32 v98, v98, v99
    v_mul_f32 v12, s89, v98
    s_waitcnt lgkmcnt(5)
    v_add_f32 v100, v100, v101
    v_fmac_f32 v11, s90, v100
    s_waitcnt lgkmcnt(4)
    v_add_f32 v102, v102, v103
    v_fmac_f32 v12, s91, v102
    s_waitcnt lgkmcnt(3)
    v_add_f32 v104, v104, v105
    v_fmac_f32 v11, s92, v104
    s_waitcnt lgkmcnt(2)
    v_add_f32 v106, v106, v107
    v_fmac_f32 v12, s93, v106
    s_waitcnt lgkmcnt(1)
    v_add_f32 v108, v108, v109
    v_fmac_f32 v11, s94, v108
    s_waitcnt lgkmcnt(0)
    v_add_f32 v110, v110, v111
    v_fmac_f32 v12, s95, v110
    v_add_f32 v12, v11, v12
    s_mov_b32 s46, 0x55555555
    s_mov_b32 s47, 0x55555555
    v_mov_b32_dpp v13, v12 quad_perm:[1,1,3,3] row_mask:0xf bank_mask:0xf
    s_mov_b64 exec, s[46:47]
    v_and_or_b32 v13, v13, s50, v5
    s_cmp_eq_u32 s42, 0
    s_cbranch_scc1 L_slow_13
    global_store_dwordx2 v7, v[12:13], s[40:41]
L_back_14:
    s_mov_b64 exec, -1
    s_branch L_w_combdone
L_w_ml:
    v_mov_b32 v11, s34
    v_mov_b32 v15, s34
    s_mov_b64 exec, 1
    s_cmp_eq_u32 s42, 0
    s_cbranch_scc1 L_slow_15
    global_store_dwordx2 v8, v[10:11], s[40:41]
L_back_16:
    s_mov_b64 exec, -1
    s_barrier
    ds_read_b32 v14, v9 offset:1796
    s_waitcnt lgkmcnt(0)
    v_mul_f32 v14, v14, v12
    s_nop 1
    v_add_f32_dpp v14, v14, v14 quad_perm:[1,0,3,2] row_mask:0xf bank_mask:0xf
    s_nop 1
    v_add_f32_dpp v14, v14, v14 quad_perm:[2,3,0,1] row_mask:0xf bank_mask:0xf
    s_nop 1
    v_add_f32_dpp v14, v14, v14 row_half_mirror row_mask:0xf bank_mask:0xf
    s_mov_b64 exec, 1
    s_cmp_eq_u32 s42, 0
    s_cbranch_scc1 L_slow_17
    global_store_dwordx2 v8, v[14:15], s[40:41] offset:8
L_back_18:
    s_mov_b64 exec, -1
    s_branch L_w_combdone
L_w_nocomb:
    s_setprio 3
    s_barrier
L_w_combdone:
    s_cmp_eq_u32 s35, 0
    s_cbranch_scc1 L_w_r0
    s_cmp_lg_u32 s39, 0
    s_cbranch_scc1 L_w_nocs0
    s_cmp_ge_u32 s32, 6
    s_cbranch_scc1 L_w_nocs0
    s_cmp_eq_u32 s35, 2
    s_cbranch_scc1 L_w_l2
    s_cmp_ge_u32 s32, 4
    s_cbranch_scc1 L_w_csg
    s_mul_i32 s46, s37, 320
    s_mul_i32 s47, s32, 80
    s_add_u32 s46, s46, s47
    s_mul_i32 s46, s46, 3072
    s_lshl_b32 s47, s36, 7
    s_add_u32 s46, s46, s47
    v_and_b32 v16, 7, v0
    v_bfe_u32 v17, v0, 3, 1
    v_bfe_u32 v18, v0, 4, 1
    v_lshl_add_u32 v17, v18, 3, v17
    v_bfe_u32 v18, v0, 5, 1
    v_lshl_add_u32 v17, v18, 1, v17
    v_mul_u32_u24 v17, 3072, v17
    v_lshl_add_u32 v17, v16, 4, v17
    v_add_u32 v17, s46, v17
    global_load_dwordx4 v[32:35], v17, s[16:17] nt
    v_add_u32 v17, 12288, v17
    global_load_dwordx4 v[36:39], v17, s[16:17] nt
    v_add_u32 v17, 36864, v17
    global_load_dwordx4 v[40:43], v17, s[16:17] nt
    v_add_u32 v17, 12288, v17
    global_load_dwordx4 v[44:47], v17, s[16:17] nt
    v_add_u32 v17, 36864, v17
    global_load_dwordx4 v[48:51], v17, s[16:17] nt
    v_add_u32 v17, 12288, v17
    global_load_dwordx4 v[52:55], v17, s[16:17] nt
    v_add_u32 v17, 36864, v17
    global_load_dwordx4 v[56:59], v17, s[16:17] nt
    v_add_u32 v17, 12288, v17
    global_load_dwordx4 v[60:63], v17, s[16:17] nt
    v_add_u32 v17, 36864, v17
    global_load_dwordx4 v[64:67], v17, s[16:17] nt
    v_add_u32 v17, 12288, v17
    global_load_dwordx4 v[68:71], v17, s[16:17] nt
    s_branch L_w_csg
L_w_l2:
    s_cmp_ge_u32 s32, 5
    s_cbranch_scc1 L_w_csg
    s_mul_i32 s46, s36, 81920
    s_mul_i32 s47, s37, 640
    s_add_u32 s46, s46, s47
    s_lshl_b32 s47, s32, 7
    s_add_u32 s46, s46, s47
    v_and_b32 v16, 7, v0
    v_bfe_u32 v17, v0, 3, 1
    v_bfe_u32 v18, v0, 4, 1
    v_lshl_add_u32 v17, v18, 3, v17
    v_bfe_u32 v18, v0, 5, 1
    v_lshl_add_u32 v17, v18, 1, v17
    v_mul_u32_u24 v17, 1280, v17
    v_lshl_add_u32 v17, v16, 4, v17
    v_add_u32 v17, s46, v17
    global_load_dwordx4 v[32:35], v17, s[20:21] nt
    v_add_u32 v17, 5120, v17
    global_load_dwordx4 v[36:39], v17, s[20:21] nt
    v_add_u32 v17, 15360, v17
    global_load_dwordx4 v[40:43], v17, s[20:21] nt
    v_add_u32 v17, 5120, v17
    global_load_dwordx4 v[44:47], v17, s[20:21] nt
    v_add_u32 v17, 15360, v17
    global_load_dwordx4 v[48:51], v17, s[20:21] nt
    v_add_u32 v17, 5120, v17
    global_load_dwordx4 v[52:55], v17, s[20:21] nt
    v_add_u32 v17, 15360, v17
    global_load_dwordx4 v[56:59], v17, s[20:21] nt
    v_add_u32 v17, 5120, v17
    global_load_dwordx4 v[60:63], v17, s[20:21] nt
    s_nop 0
L_w_csg:
    s_cmp_lg_u32 s39, 0
    s_cbranch_scc1 L_nv_19
    s_lshl_b32 s46, s28, 8
    s_add_u32 s46, s46, 0x1d8800
    v_and_b32 v5, 31, v0
    v_lshl_add_u32 v5, v5, 3, s46
    global_load_dwordx2 v[6:7], v5, s[26:27] sc1
    s_waitcnt vmcnt(0)
    v_cmp_eq_u32 s[48:49], s34, v7
    v_cmp_ne_u32 vcc, 0, v6
    s_nop 0
    s_and_b64 vcc, vcc, s[48:49]
    s_bcnt1_i32_b64 s46, vcc
    s_bcnt1_i32_b64 s47, s[48:49]
    s_lshl_b32 s46, s46, 1
    s_cmp_gt_u32 s46, s47
    s_cselect_b32 s3, 0x2000, 0
L_nv_19:
    v_mov_b32 v5, s33
    s_mov_b32 s38, 0
    s_nop 0
L_poll_20:
    global_load_dwordx4 v[12:15], v120, s[26:27] sc1
    s_waitcnt vmcnt(0)
    v_xor_b32 v13, v5, v13
    v_xor_b32 v15, v5, v15
    v_or_b32 v24, v13, v15
    v_cmp_ne_u32_sdwa vcc, v24, 0 src0_sel:BYTE_0 src1_sel:DWORD
    s_nop 0
    s_cbranch_vccnz L_retry_22
    v_permlane32_swap_b32 v12, v14
    v_permlane32_swap_b32 v13, v15
    v_add_f32 v12, v12, v14
    v_add_f32 v13, v13, v15
    s_nop 1
    v_permlane16_swap_b32 v12, v13
    v_add_f32 v12, v12, v13
    s_nop 1
    v_add_f32_dpp v12, v12, v12 row_ror:8 row_mask:0xf bank_mask:0xf
    v_mov_b32 v123, v12
    s_nop 1
L_w_nocs0:
    s_cmp_eq_u32 s35, 1
    s_cbranch_scc1 L_w_r1
    s_cmp_eq_u32 s35, 2
    s_cbranch_scc1 L_w_r2
L_w_r0:
    s_cmp_lt_u32 s32, 4
    s_cbranch_scc1 L_w_o_g
    v_and_b32 v24, 7, v0
    v_lshrrev_b32 v25, 3, v0
    v_lshl_add_u32 v9, v24, 4, s45
    v_lshl_add_u32 v10, v25, 4, s45
    global_load_dwordx2 v[18:19], v9, s[40:41] sc1
    global_load_dwordx2 v[20:21], v10, s[40:41] sc1
    v_mul_u32_u24 v8, 896, v25
    v_lshl_add_u32 v8, v24, 4, v8
    v_add_u32 v8, s44, v8
    v_mov_b32 v5, s33
    v_lshrrev_b32 v25, 4, v0
    v_lshl_add_u32 v25, v24, 2, v25
    v_add_u32 v25, s51, v25
    v_and_b32 v27, 7, v25
    v_mul_u32_u24 v11, 400, v27
    v_and_b32 v27, 0xfffffff8, v25
    v_add_u32 v11, v11, v27
    v_and_b32 v27, 8, v0
    v_lshrrev_b32 v27, 3, v27
    v_mul_u32_u24 v27, 3204, v27
    v_add_u32 v11, v11, v27
    v_add_u32 v11, 6400, v11
    s_mov_b32 s38, 0
    s_branch L_h1mw_24
L_h1m_23:
    global_load_dwordx2 v[18:19], v9, s[40:41] sc1
    global_load_dwordx2 v[20:21], v10, s[40:41] sc1
L_h1mw_24:
    s_waitcnt vmcnt(0)
    v_bitop3_b32 v24, v19, v21, s34 bitop3:0x7e
    v_cmp_ne_u32 vcc, 0, v24
    s_nop 0
    s_cbranch_vccnz L_retry_27
    global_load_dwordx2 v[16:17], v9, s[40:41] offset:8 sc1
    global_load_dwordx4 v[12:15], v8, s[40:41] sc1
    v_mov_b32 v27, v18
    s_nop 1
    v_max_f32_dpp v27, v27, v27 quad_perm:[1,0,3,2] row_mask:0xf bank_mask:0xf
    s_nop 1
    v_max_f32_dpp v27, v27, v27 quad_perm:[2,3,0,1] row_mask:0xf bank_mask:0xf
    s_nop 1
    v_max_f32_dpp v27, v27, v27 row_half_mirror row_mask:0xf bank_mask:0xf
    v_sub_f32 v18, v18, v27
    v_sub_f32 v20, v20, v27
    v_exp_f32 v4, v18
    v_exp_f32 v10, v20
    s_nop 0
    s_branch L_h1dw_26
L_h1d_25:
    global_load_dwordx2 v[16:17], v9, s[40:41] offset:8 sc1
    global_load_dwordx4 v[12:15], v8, s[40:41] sc1
L_h1dw_26:
    s_waitcnt vmcnt(0)
    v_xor_b32 v13, v5, v13
    v_xor_b32 v15, v5, v15
    v_or_b32 v24, v13, v15
    v_bitop3_b32 v25, v17, v17, s34 bitop3:0x7e
    v_or_b32_sdwa v24, v24, v25 dst_sel:DWORD dst_unused:UNUSED_PAD src0_sel:BYTE_0 src1_sel:DWORD
    v_cmp_ne_u32 vcc, 0, v24
    v_mul_f32 v28, v12, v10
    v_mul_f32 v29, v13, v10
    v_mul_f32 v30, v14, v10
    v_mul_f32 v31, v15, v10
    v_mul_f32 v27, v16, v4
    s_nop 0
    s_cbranch_vccnz L_retry_28
    v_permlane32_swap_b32 v28, v30
    v_permlane32_swap_b32 v29, v31
    v_add_f32_dpp v27, v27, v27 quad_perm:[1,0,3,2] row_mask:0xf bank_mask:0xf
    v_add_f32 v28, v28, v30
    v_add_f32 v29, v29, v31
    v_add_f32_dpp v27, v27, v27 quad_perm:[2,3,0,1] row_mask:0xf bank_mask:0xf
    s_nop 0
    v_permlane16_swap_b32 v28, v29
    v_add_f32 v28, v28, v29
    v_add_f32_dpp v27, v27, v27 row_half_mirror row_mask:0xf bank_mask:0xf
    v_rcp_f32 v27, v27
    v_add_f32_dpp v28, v28, v28 row_ror:8 row_mask:0xf bank_mask:0xf
    v_mul_f32 v28, v28, v27
    v_cvt_pk_bf16_f32 v28, v28, v28
    ds_write_b16 v11, v28
    s_waitcnt lgkmcnt(0)
    s_barrier
    s_waitcnt vmcnt(0)
    s_barrier
    s_branch L_w_roledone
L_w_o_g:
    s_mul_i32 s46, s32, 96
    v_add_u32 v6, s46, v122
    v_and_b32 v7, 7, v0
    v_lshlrev_b32 v7, 5, v7
    v_bfe_u32 v8, v0, 4, 1
    v_lshl_add_u32 v7, v8, 4, v7
    v_lshrrev_b32 v8, 5, v0
    v_lshl_add_u32 v7, v8, 8, v7
    s_lshl_b32 s46, s32, 9
    s_add_u32 s46, s46, 46592
    v_add_u32 v7, s46, v7
    v_mov_b32 v5, s33
    v_lshlrev_b32 v12, 2, v0
    s_lshl_b32 s46, s28, 1
    s_add_u32 s46, s46, s36
    s_lshr_b32 s47, s46, 3
    s_mul_i32 s47, s47, 2688
    s_and_b32 s46, s46, 7
    s_lshl_b32 s46, s46, 14
    s_add_u32 s46, s46, s47
    s_lshl_b32 s47, s37, 8
    s_add_u32 s46, s46, s47
    s_add_u32 s46, s46, 0x84000
    v_add_u32 v13, s46, v12
    v_add_u32 v24, 0x2000, v13
    v_add_u32 v12, 46592, v12
    s_lshl_b32 s48, s28, 7
    s_lshl_b32 s49, s29, 2
    s_add_u32 s48, s48, s49
    s_add_u32 s48, s48, 0x74000
    v_mov_b32 v14, s48
    v_mov_b32 v15, s34
    v_mov_b32 v8, 0
    v_mov_b32 v9, 0
    v_mov_b32 v10, 0
    v_mov_b32 v11, 0
    s_waitcnt vmcnt(0)
    s_barrier
    ds_read_b128 v[80:83], v6 offset:6400
    ds_read_b128 v[84:87], v6 offset:6416
    ds_read_b128 v[88:91], v6 offset:6432
    ds_read_b128 v[92:95], v6 offset:6448
    ds_read_b128 v[96:99], v6 offset:6464
    ds_read_b128 v[100:103], v6 offset:6480
    s_waitcnt lgkmcnt(5)
    v_smfmac_f32_16x16x64_bf16 v[8:11], v[80:83], v[32:39], v1
    s_waitcnt lgkmcnt(4)
    v_smfmac_f32_16x16x64_bf16 v[8:11], v[84:87], v[40:47], v1
    s_waitcnt lgkmcnt(3)
    v_smfmac_f32_16x16x64_bf16 v[8:11], v[88:91], v[48:55], v1
    s_waitcnt lgkmcnt(2)
    v_smfmac_f32_16x16x64_bf16 v[8:11], v[92:95], v[56:63], v1
    s_waitcnt lgkmcnt(1)
    v_smfmac_f32_16x16x64_bf16 v[8:11], v[96:99], v[64:71], v1
    s_waitcnt lgkmcnt(0)
    v_smfmac_f32_16x16x64_bf16 v[8:11], v[100:103], v[72:79], v1
    s_mov_b64 exec, s[52:53]
    s_nop 6
    ds_write_b128 v7, v[8:11]
    s_mov_b64 exec, -1
    s_waitcnt lgkmcnt(0)
    s_barrier
    s_cmp_lg_u32 s32, 0
    s_cbranch_scc1 L_w_roledone
    ds_read2st64_b32 v[16:17], v12 offset0:0 offset1:1
    ds_read2st64_b32 v[18:19], v12 offset0:2 offset1:3
    ds_read2st64_b32 v[20:21], v12 offset0:4 offset1:5
    ds_read2st64_b32 v[22:23], v12 offset0:6 offset1:7
    s_waitcnt lgkmcnt(2)
    v_add_f32 v16, v16, v17
    v_add_f32 v18, v18, v19
    s_waitcnt lgkmcnt(0)
    v_add_f32 v20, v20, v21
    v_add_f32 v22, v22, v23
    v_add_f32 v16, v16, v18
    v_add_f32 v20, v20, v22
    v_add_f32 v16, v16, v20
    s_mov_b32 s46, 0x55555555
    s_mov_b32 s47, 0x55555555
    v_mov_b32_dpp v17, v16 quad_perm:[1,1,3,3] row_mask:0xf bank_mask:0xf
    s_mov_b64 exec, s[46:47]
    v_and_or_b32 v17, v17, s50, v5
    global_store_dwordx2 v13, v[16:17], s[40:41] sc1
    global_store_dwordx2 v24, v[16:17], s[40:41] sc1
    s_mov_b64 exec, -1
    s_mov_b64 exec, 1
    global_store_dword v14, v15, s[40:41]
    s_mov_b64 exec, -1
    s_branch L_w_roledone
L_w_r1:
    s_cmp_lt_u32 s32, 4
    s_cbranch_scc1 L_w_1_g
    s_cmp_eq_u32 s32, 4
    s_cbranch_scc1 L_w_1_idle
    s_cmp_eq_u32 s32, 7
    s_cbranch_scc1 L_w_1_st
    s_add_u32 s56, s32, 3
    s_cmp_lg_u32 s39, 0
    s_cbranch_scc1 L_nv_29
    s_lshl_b32 s46, s28, 8
    s_add_u32 s46, s46, 0x1d8800
    v_and_b32 v5, 31, v0
    v_lshl_add_u32 v5, v5, 3, s46
    global_load_dwordx2 v[6:7], v5, s[26:27] sc1
    s_waitcnt vmcnt(0)
    v_cmp_eq_u32 s[48:49], s34, v7
    v_cmp_ne_u32 vcc, 0, v6
    s_nop 0
    s_and_b64 vcc, vcc, s[48:49]
    s_bcnt1_i32_b64 s46, vcc
    s_bcnt1_i32_b64 s47, s[48:49]
    s_lshl_b32 s46, s46, 1
    s_cmp_gt_u32 s46, s47
    s_cselect_b32 s3, 0x2000, 0
L_nv_29:
    v_mov_b32 v5, s33
    v_and_b32 v24, 7, v0
    v_lshrrev_b32 v25, 3, v0
    s_mul_i32 s46, s37, 1280
    s_lshl_b32 s47, s56, 7
    s_add_u32 s46, s46, s47
    s_add_u32 s48, s46, 0x84000
    s_add_u32 s48, s48, s3
    v_lshlrev_b32 v8, 14, v25
    v_lshl_add_u32 v8, v24, 4, v8
    v_add_u32 v8, s48, v8
    v_add_u32 v9, 2688, v8
    v_lshrrev_b32 v25, 4, v0
    v_lshl_add_u32 v25, v24, 2, v25
    s_lshl_b32 s47, s56, 5
    v_add_u32 v25, s47, v25
    v_and_b32 v27, 7, v25
    v_mul_u32_u24 v10, 400, v27
    v_and_b32 v27, 0xfffffff8, v25
    v_add_u32 v10, v10, v27
    v_and_b32 v27, 8, v0
    v_lshrrev_b32 v27, 3, v27
    v_mul_u32_u24 v27, 3204, v27
    v_add_u32 v10, v10, v27
    v_add_u32 v10, 6400, v10
    s_mul_i32 s47, s37, 320
    v_add_u32 v25, s47, v25
    s_cmp_lg_u32 s39, 0
    s_cbranch_scc1 L_h2k1_30
    v_lshlrev_b32 v11, 1, v25
    global_load_ushort v22, v11, s[4:5]
    s_waitcnt vmcnt(0)
    v_lshlrev_b32 v22, 16, v22
    s_nop 0
    s_branch L_h2j_31
L_h2k1_30:
    v_lshlrev_b32 v11, 2, v25
    v_add_u32 v11, 0x1d0000, v11
    s_mov_b32 s38, 0
    s_nop 0
L_poll_32:
    global_load_dword v22, v11, s[26:27] sc1
    s_waitcnt vmcnt(0)
    v_xor_b32 v22, v5, v22
    v_cmp_ne_u32_sdwa vcc, v22, 0 src0_sel:BYTE_0 src1_sel:DWORD
    s_nop 0
    s_cbranch_vccnz L_retry_34
    v_and_b32 v22, s57, v22
    s_nop 1
L_h2j_31:
    v_lshlrev_b32 v11, 2, v25
    v_add_u32 v11, 0x85500, v11
    s_barrier
    s_mov_b32 s38, 0
L_poll_35:
    global_load_dwordx4 v[12:15], v8, s[40:41] sc1
    global_load_dwordx4 v[16:19], v9, s[40:41] sc1
    s_waitcnt vmcnt(0)
    v_xor_b32 v13, v5, v13
    v_xor_b32 v15, v5, v15
    v_xor_b32 v17, v5, v17
    v_xor_b32 v19, v5, v19
    v_or3_b32 v24, v13, v15, v17
    v_or_b32 v24, v24, v19
    v_cmp_ne_u32_sdwa vcc, v24, 0 src0_sel:BYTE_0 src1_sel:DWORD
    s_nop 0
    s_cbranch_vccnz L_retry_37
    v_add_f32 v12, v12, v16
    v_add_f32 v13, v13, v17
    v_add_f32 v14, v14, v18
    v_add_f32 v15, v15, v19
    s_nop 0
    v_permlane32_swap_b32 v12, v14
    v_permlane32_swap_b32 v13, v15
    v_add_f32 v12, v12, v14
    v_add_f32 v13, v13, v15
    s_nop 1
    v_permlane16_swap_b32 v12, v13
    v_add_f32 v12, v12, v13
    s_nop 1
    v_add_f32_dpp v12, v12, v12 row_ror:8 row_mask:0xf bank_mask:0xf
    v_cvt_pk_bf16_f32 v12, v12, v12
    v_and_b32 v12, s57, v12
    v_add_f32 v12, v12, v22
    v_cvt_pk_bf16_f32 v12, v12, v12
    ds_write_b16 v10, v12
    s_cmp_lg_u32 s36, 0
    s_cbranch_scc1 L_h2s_38
    v_and_or_b32 v12, v12, s57, v5
    s_mov_b64 exec, s[54:55]
    global_store_dword v11, v12, s[40:41] sc1
    v_add_u32 v11, 0x2000, v11
    global_store_dword v11, v12, s[40:41] sc1
    s_mov_b64 exec, -1
L_h2s_38:
    s_waitcnt lgkmcnt(0)
    s_barrier
    s_branch L_w_roledone
L_w_1_idle:
    s_lshl_b32 s46, s28, 7
    s_add_u32 s46, s46, 0x74000
    v_min_u32 v5, 19, v0
    v_lshl_add_u32 v5, v5, 2, s46
    s_cmp_eq_u32 s42, 0
    s_cbranch_scc1 L_sentd_40
    s_mov_b32 s38, 0
L_sent_39:
    global_load_dword v6, v5, s[40:41] sc1
    s_waitcnt vmcnt(0)
    v_cmp_ne_u32 vcc, s34, v6
    s_nop 0
    s_cbranch_vccnz L_retry_41
L_sentd_40:
    s_barrier
    s_barrier
    s_branch L_w_roledone
L_w_1_st:
    v_and_b32 v8, 7, v0
    v_lshrrev_b32 v5, 3, v0
    v_mul_u32_u24 v5, 400, v5
    v_lshl_add_u32 v5, v8, 3, v5
    s_lshl_b32 s46, s36, 7
    s_lshl_b32 s47, s37, 4
    s_add_u32 s46, s46, s47
    s_add_u32 s46, s46, 0x73000
    v_lshrrev_b32 v8, 5, v0
    v_lshl_add_u32 v4, v8, 3, s46
    v_mov_b32 v9, s33
    v_mov_b32 v10, 0
    v_mov_b32 v11, 0
    v_mov_b32 v12, 0
    v_mov_b32 v13, 0
    v_mov_b32 v14, 0
    v_mov_b32 v17, s34
    s_barrier
    s_barrier
    ds_read_u16_d16_hi v10, v5 offset:6400
    ds_read_u16_d16_hi v11, v5 offset:6464
    ds_read_u16_d16_hi v12, v5 offset:6528
    ds_read_u16_d16_hi v13, v5 offset:6592
    ds_read_u16_d16_hi v14, v5 offset:6656
    s_waitcnt lgkmcnt(3)
    v_mul_f32 v7, v10, v10
    v_add_f32 v16, v10, v11
    v_fmac_f32 v7, v11, v11
    s_waitcnt lgkmcnt(2)
    v_add_f32 v16, v16, v12
    v_fmac_f32 v7, v12, v12
    s_waitcnt lgkmcnt(1)
    v_add_f32 v16, v16, v13
    v_fmac_f32 v7, v13, v13
    s_waitcnt lgkmcnt(0)
    v_add_f32 v16, v16, v14
    v_fmac_f32 v7, v14, v14
    s_nop 1
    v_permlane32_swap_b32 v16, v7
    v_add_f32 v16, v16, v7
    s_nop 1
    v_add_f32_dpp v16, v16, v16 quad_perm:[1,0,3,2] row_mask:0xf bank_mask:0xf
    s_nop 1
    v_add_f32_dpp v16, v16, v16 quad_perm:[2,3,0,1] row_mask:0xf bank_mask:0xf
    s_nop 1
    v_add_f32_dpp v16, v16, v16 row_half_mirror row_mask:0xf bank_mask:0xf
    s_nop 1
    v_add_f32_dpp v16, v16, v16 row_ror:8 row_mask:0xf bank_mask:0xf
    s_nop 1
    v_add_f32_dpp v16, v16, v16 row_bcast:15 row_mask:0xa bank_mask:0xf
    s_mov_b32 exec_lo, 0x10000
    s_mov_b32 exec_hi, 0x10000
    s_cmp_eq_u32 s42, 0
    s_cbranch_scc1 L_slow_42
    global_store_dwordx2 v4, v[16:17], s[40:41]
L_back_43:
    s_mov_b64 exec, -1
    s_branch L_w_roledone
L_w_1_g:
    s_mul_i32 s46, s32, 80
    v_add_u32 v6, s46, v122
    v_mov_b32 v5, s33
    s_lshl_b32 s46, s36, 1
    s_add_u32 s46, s46, s37
    s_lshl_b32 s46, s46, 2
    s_add_u32 s46, s46, s32
    s_lshl_b32 s46, s46, 8
    v_add_u32 v7, s46, v126
    s_waitcnt vmcnt(0)
    s_cmp_lg_u32 s39, 0
    s_cbranch_scc1 L_w_1_nocs
    v_mov_b32 v8, 0
    v_mov_b32 v9, 0
    v_mov_b32 v10, 0
    v_mov_b32 v11, 0
    v_and_b32 v16, 0x3f80, v2
    v_and_b32 v17, 0x3f80, v3
    v_and_b32 v18, 0x3f80, v2
    v_and_b32 v19, 0x3f80, v3
    s_nop 1
    v_smfmac_f32_16x16x64_bf16 v[8:11], v[16:19], v[32:39], v1
    v_smfmac_f32_16x16x64_bf16 v[8:11], v[16:19], v[40:47], v1
    v_smfmac_f32_16x16x64_bf16 v[8:11], v[16:19], v[48:55], v1
    v_smfmac_f32_16x16x64_bf16 v[8:11], v[16:19], v[56:63], v1
    v_smfmac_f32_16x16x64_bf16 v[8:11], v[16:19], v[64:71], v1
    s_nop 7
    v_permlane32_swap_b32 v8, v10
    v_permlane32_swap_b32 v9, v11
    s_nop 0
    v_add_f32_dpp v12, v10, v8 row_ror:8 row_mask:0xf bank_mask:0xf
    v_add_f32_dpp v13, v11, v9 row_ror:8 row_mask:0xf bank_mask:0xf
    v_add_u32 v14, 0x1c0000, v7
    v_and_or_b32 v13, v13, s50, v5
    s_mov_b64 exec, s[54:55]
    s_cmp_eq_u32 s42, 0
    s_cbranch_scc1 L_slow_44
    global_store_dwordx2 v14, v[12:13], s[26:27]
L_back_45:
    s_mov_b64 exec, -1
L_w_1_nocs:
    v_add_u32 v7, 0x78000, v7
    v_mov_b32 v8, 0
    v_mov_b32 v9, 0
    v_mov_b32 v10, 0
    v_mov_b32 v11, 0
    s_barrier
    s_barrier
    ds_read_b128 v[80:83], v6 offset:6400
    ds_read_b128 v[84:87], v6 offset:6416
    ds_read_b128 v[88:91], v6 offset:6432
    ds_read_b128 v[92:95], v6 offset:6448
    ds_read_b128 v[96:99], v6 offset:6464
    s_waitcnt lgkmcnt(4)
    v_smfmac_f32_16x16x64_bf16 v[8:11], v[80:83], v[32:39], v1
    s_waitcnt lgkmcnt(3)
    v_smfmac_f32_16x16x64_bf16 v[8:11], v[84:87], v[40:47], v1
    s_waitcnt lgkmcnt(2)
    v_smfmac_f32_16x16x64_bf16 v[8:11], v[88:91], v[48:55], v1
    s_waitcnt lgkmcnt(1)
    v_smfmac_f32_16x16x64_bf16 v[8:11], v[92:95], v[56:63], v1
    s_waitcnt lgkmcnt(0)
    v_smfmac_f32_16x16x64_bf16 v[8:11], v[96:99], v[64:71], v1
    s_nop 7
    v_permlane32_swap_b32 v8, v10
    v_permlane32_swap_b32 v9, v11
    s_nop 0
    v_add_f32_dpp v12, v10, v8 row_ror:8 row_mask:0xf bank_mask:0xf
    v_add_f32_dpp v13, v11, v9 row_ror:8 row_mask:0xf bank_mask:0xf
    v_and_or_b32 v13, v13, s50, v5
    s_mov_b64 exec, s[54:55]
    s_cmp_eq_u32 s42, 0
    s_cbranch_scc1 L_slow_46
    global_store_dwordx2 v7, v[12:13], s[40:41]
L_back_47:
    s_mov_b64 exec, -1
    s_branch L_w_roledone
L_w_r2:
    s_cmp_lt_u32 s32, 5
    s_cbranch_scc1 L_w_2_g
    s_cmp_lg_u32 s32, 5
    s_cbranch_scc1 L_w_2_idle
    v_mov_b32 v5, s33
    v_and_b32 v24, 7, v0
    v_lshrrev_b32 v25, 3, v0
    s_lshl_b32 s46, s36, 11
    v_lshlrev_b32 v6, 8, v25
    v_lshl_add_u32 v6, v24, 4, v6
    v_add_u32 v6, s46, v6
    s_lshl_b32 s46, s36, 7
    s_add_u32 s46, s46, 0x73000
    v_mov_b32 v7, s46
    v_lshrrev_b32 v25, 4, v0
    v_lshl_add_u32 v25, v24, 2, v25
    v_and_b32 v27, 8, v0
    v_lshl_add_u32 v25, v27, 2, v25
    v_and_b32 v27, 7, v25
    v_mul_u32_u24 v8, 400, v27
    v_and_b32 v27, 0xfffffff8, v25
    v_add_u32 v8, v8, v27
    v_and_b32 v27, 8, v0
    v_cmp_eq_u32 s[58:59], 0, v27
    s_cmp_lg_u32 s39, 0
    s_nop 2
    s_cbranch_scc1 L_w_2_nocs
    s_lshl_b32 s46, s36, 7
    v_lshl_add_u32 v9, v25, 1, s46
    global_load_ushort v125, v9, s[18:19]
    v_add_u32 v9, 0x1c0000, v6
    s_mov_b32 s38, 0
    s_nop 0
L_poll_48:
    global_load_dwordx4 v[12:15], v9, s[26:27] sc1
    global_load_dwordx4 v[16:19], v9, s[26:27] offset:128 sc1
    s_waitcnt vmcnt(0)
    v_xor_b32 v13, v5, v13
    v_xor_b32 v15, v5, v15
    v_xor_b32 v17, v5, v17
    v_xor_b32 v19, v5, v19
    v_or3_b32 v24, v13, v15, v17
    v_or_b32 v24, v24, v19
    v_cmp_ne_u32_sdwa vcc, v24, 0 src0_sel:BYTE_0 src1_sel:DWORD
    s_nop 0
    s_cbranch_vccnz L_retry_50
    v_permlane32_swap_b32 v12, v14
    v_permlane32_swap_b32 v13, v15
    v_permlane32_swap_b32 v16, v18
    v_permlane32_swap_b32 v17, v19
    v_add_f32 v12, v12, v14
    v_add_f32 v13, v13, v15
    v_add_f32 v16, v16, v18
    v_add_f32 v17, v17, v19
    v_permlane16_swap_b32 v12, v13
    s_nop 0
    v_permlane16_swap_b32 v16, v17
    v_add_f32 v12, v12, v13
    v_add_f32 v16, v16, v17
    v_cndmask_b32 v14, v12, v16, s[58:59]
    v_cndmask_b32 v13, v16, v12, s[58:59]
    s_nop 1
    v_add_f32_dpp v12, v14, v13 row_ror:8 row_mask:0xf bank_mask:0xf
    v_mov_b32 v124, v12
    v_lshlrev_b32 v125, 16, v125
    s_nop 1
L_w_2_nocs:
    v_add_u32 v6, 0x78000, v6
    v_mov_b32 v10, 0
    v_mov_b32 v11, 0
    s_mov_b32 s38, 0
    s_nop 0
L_poll_51:
    global_load_dwordx4 v[20:23], v7, s[40:41] sc1
    global_load_dwordx4 v[28:31], v7, s[40:41] offset:16 sc1
    global_load_dwordx4 v[12:15], v6, s[40:41] sc1
    global_load_dwordx4 v[16:19], v6, s[40:41] offset:128 sc1
    s_waitcnt vmcnt(0)
    v_xor_b32 v13, v5, v13
    v_xor_b32 v15, v5, v15
    v_xor_b32 v17, v5, v17
    v_xor_b32 v19, v5, v19
    v_or3_b32 v24, v13, v15, v17
    v_or_b32 v24, v24, v19
    v_bitop3_b32 v25, v21, v23, s34 bitop3:0x7e
    v_bitop3_b32 v26, v29, v31, s34 bitop3:0x7e
    v_or_b32 v25, v25, v26
    v_or_b32_sdwa v24, v24, v25 dst_sel:DWORD dst_unused:UNUSED_PAD src0_sel:BYTE_0 src1_sel:DWORD
    v_cmp_ne_u32 vcc, 0, v24
    s_nop 0
    s_cbranch_vccnz L_retry_53
    v_add_f32 v20, v20, v28
    v_add_f32 v21, v22, v30
    v_mul_f32 v20, 0x3acccccd, v20
    v_mul_f32 v21, 0x3acccccd, v21
    v_fma_f32 v21, -v20, v20, v21
    v_max_f32 v21, 0, v21
    v_add_f32 v21, 0x3727c5ac, v21
    v_rsq_f32 v21, v21
    v_permlane32_swap_b32 v12, v14
    v_permlane32_swap_b32 v13, v15
    v_permlane32_swap_b32 v16, v18
    v_permlane32_swap_b32 v17, v19
    v_add_f32 v12, v12, v14
    v_add_f32 v13, v13, v15
    v_add_f32 v16, v16, v18
    v_add_f32 v17, v17, v19
    v_permlane16_swap_b32 v12, v13
    s_nop 0
    v_permlane16_swap_b32 v16, v17
    v_add_f32 v12, v12, v13
    v_add_f32 v16, v16, v17
    v_cndmask_b32 v14, v12, v16, s[58:59]
    v_cndmask_b32 v13, v16, v12, s[58:59]
    s_nop 1
    v_add_f32_dpp v12, v14, v13 row_ror:8 row_mask:0xf bank_mask:0xf
    v_fma_f32 v12, -v20, v124, v12
    v_fma_f32 v12, v12, v21, v125
    v_mul_f32 v16, 0x3fb8aa3b, v12
    v_exp_f32 v16, -abs(v16)
    v_cmp_le_f32 vcc, 0, v12
    v_fma_f32 v17, v16, 2.0, 1.0
    v_add_f32 v19, 2.0, v16
    v_mul_f32 v18, v16, v16
    v_mul_f32 v19, v19, v16
    v_cndmask_b32 v18, 1.0, v18, vcc
    v_cndmask_b32 v17, v19, v17, vcc
    v_fma_f32 v18, v18, 2.0, v17
    v_rcp_f32 v18, v18
    v_mul_f32 v17, v17, v12
    v_mul_f32 v17, v17, v18
    v_cvt_pk_bf16_f32 v17, v17, v17
    ds_write_b16 v8, v17 offset:6400
    ds_write_b16 v8, v17 offset:9604
    s_waitcnt lgkmcnt(0)
L_w_2_idle:
    s_barrier
    s_branch L_w_roledone
L_w_2_g:
    v_mov_b32 v5, s33
    s_lshr_b32 s47, s36, 3
    s_mul_i32 s47, s47, 2688
    s_and_b32 s46, s36, 7
    s_lshl_b32 s46, s46, 14
    s_add_u32 s46, s46, s47
    s_mul_i32 s47, s37, 1280
    s_add_u32 s46, s46, s47
    s_lshl_b32 s47, s32, 8
    s_add_u32 s46, s46, s47
    s_add_u32 s46, s46, 0xa4000
    v_add_u32 v7, s46, v126
    v_add_u32 v24, 0x2000, v7
    s_sub_u32 s46, s29, 26
    s_mul_i32 s46, s46, 5
    s_add_u32 s46, s46, s32
    s_lshl_b32 s48, s28, 7
    s_lshl_b32 s49, s46, 2
    s_add_u32 s48, s48, s49
    s_add_u32 s48, s48, 0x75000
    v_mov_b32 v14, s48
    v_mov_b32 v15, s34
    v_mov_b32 v8, 0
    v_mov_b32 v9, 0
    v_mov_b32 v10, 0
    v_mov_b32 v11, 0
    s_waitcnt vmcnt(0)
    s_barrier
    s_mov_b64 exec, 1
    global_store_dword v14, v15, s[40:41]
    s_mov_b64 exec, -1
    ds_read_b128 v[80:83], v122 offset:6400
    ds_read_b128 v[84:87], v122 offset:6416
    ds_read_b128 v[88:91], v122 offset:6432
    ds_read_b128 v[92:95], v122 offset:6448
    s_waitcnt lgkmcnt(3)
    v_smfmac_f32_16x16x64_bf16 v[8:11], v[80:83], v[32:39], v1
    s_waitcnt lgkmcnt(2)
    v_smfmac_f32_16x16x64_bf16 v[8:11], v[84:87], v[40:47], v1
    s_waitcnt lgkmcnt(1)
    v_smfmac_f32_16x16x64_bf16 v[8:11], v[88:91], v[48:55], v1
    s_waitcnt lgkmcnt(0)
    v_smfmac_f32_16x16x64_bf16 v[8:11], v[92:95], v[56:63], v1
    s_nop 7
    v_permlane32_swap_b32 v8, v10
    v_permlane32_swap_b32 v9, v11
    s_nop 0
    v_add_f32_dpp v12, v10, v8 row_ror:8 row_mask:0xf bank_mask:0xf
    v_add_f32_dpp v13, v11, v9 row_ror:8 row_mask:0xf bank_mask:0xf
    v_and_or_b32 v13, v13, s50, v5
    s_mov_b64 exec, s[54:55]
    global_store_dwordx2 v7, v[12:13], s[40:41] sc1
    global_store_dwordx2 v24, v[12:13], s[40:41] sc1
    s_mov_b64 exec, -1
L_w_roledone:
    s_cmp_eq_u32 s39, 0
    s_cbranch_scc1 L_w_h4
    s_cmp_lg_u32 s30, 0
    s_cbranch_scc1 L_end
    s_cmp_ge_u32 s32, 5
    s_cbranch_scc1 L_end
L_w_h4:
    s_cmp_lg_u32 s39, 0
    s_cbranch_scc1 L_w_nopf1
    s_cmp_ge_u32 s32, 6
    s_cbranch_scc1 L_w_nocsg
    s_cmp_lg_u32 s35, 0
    s_cbranch_scc1 L_w_nocsg
    s_cmp_lg_u32 s39, 0
    s_cbranch_scc1 L_nv_54
    s_lshl_b32 s46, s28, 8
    s_add_u32 s46, s46, 0x1d8800
    v_and_b32 v5, 31, v0
    v_lshl_add_u32 v5, v5, 3, s46
    global_load_dwordx2 v[6:7], v5, s[26:27] sc1
    s_waitcnt vmcnt(0)
    v_cmp_eq_u32 s[48:49], s34, v7
    v_cmp_ne_u32 vcc, 0, v6
    s_nop 0
    s_and_b64 vcc, vcc, s[48:49]
    s_bcnt1_i32_b64 s46, vcc
    s_bcnt1_i32_b64 s47, s[48:49]
    s_lshl_b32 s46, s46, 1
    s_cmp_gt_u32 s46, s47
    s_cselect_b32 s3, 0x2000, 0
L_nv_54:
    v_mov_b32 v5, s33
    s_mov_b32 s38, 0
    s_nop 0
L_poll_55:
    global_load_dwordx4 v[12:15], v120, s[26:27] sc1
    s_waitcnt vmcnt(0)
    v_xor_b32 v13, v5, v13
    v_xor_b32 v15, v5, v15
    v_or_b32 v24, v13, v15
    v_cmp_ne_u32_sdwa vcc, v24, 0 src0_sel:BYTE_0 src1_sel:DWORD
    s_nop 0
    s_cbranch_vccnz L_retry_57
    v_permlane32_swap_b32 v12, v14
    v_permlane32_swap_b32 v13, v15
    v_add_f32 v12, v12, v14
    v_add_f32 v13, v13, v15
    s_nop 1
    v_permlane16_swap_b32 v12, v13
    v_add_f32 v12, v12, v13
    s_nop 1
    v_add_f32_dpp v12, v12, v12 row_ror:8 row_mask:0xf bank_mask:0xf
    v_mov_b32 v123, v12
    s_nop 1
L_w_nocsg:
    s_cmp_lg_u32 s32, 7
    s_cbranch_scc1 L_w_nopf1
    s_lshl_b32 s46, s30, 3
    s_add_u32 s46, s46, s31
    s_mul_i32 s46, s46, 896
    s_add_u32 s46, s46, 0xc4000
    v_min_u32 v5, 47, v0
    v_lshl_add_u32 v5, v5, 4, s46
    v_add_u32 v6, 0x38000, v5
    s_lshl_b32 s46, s30, 7
    s_add_u32 s46, s46, 0x134000
    s_lshl_b32 s47, s28, 7
    s_add_u32 s48, s47, 0x138000
    s_add_u32 s49, s47, 0x139000
    s_mul_i32 s47, s28, 6144
    s_add_u32 s47, s47, 0x13c000
    v_min_u32 v7, 47, v0
    v_lshl_add_u32 v7, v7, 7, s47
    s_mul_i32 s47, s28, 384
    s_add_u32 s47, s47, 0x137000
    v_min_u32 v8, 2, v0
    v_lshl_add_u32 v8, v8, 7, s47
    v_writelane_b32 v8, s46, 3
    v_writelane_b32 v8, s48, 4
    v_writelane_b32 v8, s49, 5
    s_add_u32 s46, s46, 0x2000
    v_writelane_b32 v8, s46, 6
    global_load_dwordx4 v[64:67], v5, s[40:41] sc1
    global_load_dwordx4 v[68:71], v6, s[40:41] sc1
    global_load_dword v72, v7, s[40:41] sc1
    global_load_dword v73, v8, s[40:41] sc1
L_w_nopf1:
    s_cmp_lt_u32 s32, 5
    s_cbranch_scc1 L_w_h4g
    s_cmp_lg_u32 s32, 6
    s_cbranch_scc1 L_w_h4b
    s_lshl_b32 s46, s28, 7
    s_add_u32 s46, s46, 0x75000
    v_min_u32 v5, 29, v0
    v_lshl_add_u32 v5, v5, 2, s46
    s_cmp_eq_u32 s42, 0
    s_cbranch_scc1 L_sentd_59
    s_mov_b32 s38, 0
L_sent_58:
    global_load_dword v6, v5, s[40:41] sc1
    s_waitcnt vmcnt(0)
    v_cmp_ne_u32 vcc, s34, v6
    s_nop 0
    s_cbranch_vccnz L_retry_60
L_sentd_59:
L_w_h4b:
    s_barrier
    s_branch L_w_next
L_w_h4g:
    v_mov_b32 v5, s33
    v_and_b32 v24, 3, v0
    v_lshrrev_b32 v25, 4, v0
    v_lshl_add_u32 v25, v24, 2, v25
    s_lshl_b32 s46, s32, 4
    v_add_u32 v25, s46, v25
    v_and_b32 v27, 7, v25
    v_mul_u32_u24 v10, 400, v27
    v_and_b32 v27, 0xfffffff8, v25
    v_add_u32 v10, v10, v27
    v_and_b32 v27, 8, v0
    v_lshrrev_b32 v27, 3, v27
    v_mul_u32_u24 v27, 3204, v27
    v_add_u32 v10, v10, v27
    s_mul_i32 s47, s31, 80
    v_add_u32 v23, s47, v25
    v_lshrrev_b32 v27, 2, v0
    v_and_b32 v8, 7, v27
    v_lshlrev_b32 v8, 14, v8
    v_lshrrev_b32 v27, 3, v27
    v_mul_u32_u24 v27, 2688, v27
    v_add_u32 v8, v8, v27
    v_lshl_add_u32 v8, v24, 4, v8
    s_mul_i32 s46, s31, 320
    s_lshl_b32 s47, s32, 6
    s_add_u32 s46, s46, s47
    s_add_u32 s46, s46, 0xa4000
    s_add_u32 s46, s46, s3
    v_add_u32 v8, s46, v8
    v_add_u32 v9, 5376, v8
    v_lshlrev_b32 v11, 2, v23
    v_add_u32 v11, 0x85500, v11
    v_add_u32 v11, s3, v11
    v_mov_b32 v6, 0
    s_mov_b32 exec_hi, 0
    v_mov_b32 v6, v5
    s_mov_b32 exec_hi, -1
    v_mov_b32 v16, 0
    v_mov_b32 v17, 0
    v_mov_b32 v18, 0
    v_mov_b32 v19, 0
    s_cmp_lg_u32 s39, 0
    s_cbranch_scc1 L_w_nosent
    s_barrier
L_w_nosent:
    s_mov_b32 s38, 0
L_poll_61:
    global_load_dword v22, v11, s[40:41] sc1
    global_load_dwordx4 v[12:15], v8, s[40:41] sc1
    s_mov_b32 exec_hi, 0
    global_load_dwordx4 v[16:19], v9, s[40:41] sc1
    s_mov_b32 exec_hi, -1
    s_waitcnt vmcnt(0)
    v_xor_b32 v13, v5, v13
    v_xor_b32 v15, v5, v15
    v_xor_b32 v17, v6, v17
    v_xor_b32 v19, v6, v19
    v_xor_b32 v22, v5, v22
    v_or3_b32 v24, v13, v15, v17
    v_or3_b32 v24, v24, v19, v22
    v_cmp_ne_u32_sdwa vcc, v24, 0 src0_sel:BYTE_0 src1_sel:DWORD
    s_nop 0
    s_cbranch_vccnz L_retry_63
    v_add_f32 v12, v12, v16
    v_add_f32 v13, v13, v17
    v_add_f32 v14, v14, v18
    v_add_f32 v15, v15, v19
    s_nop 0
    v_permlane32_swap_b32 v12, v14
    v_permlane32_swap_b32 v13, v15
    v_add_f32 v12, v12, v14
    v_add_f32 v13, v13, v15
    s_nop 1
    v_permlane16_swap_b32 v12, v13
    v_add_f32 v12, v12, v13
    s_nop 1
    v_add_f32_dpp v12, v12, v12 row_ror:8 row_mask:0xf bank_mask:0xf
    s_nop 1
    v_add_f32_dpp v12, v12, v12 row_ror:4 row_mask:0xf bank_mask:0xf
    v_cvt_pk_bf16_f32 v12, v12, v12
    v_and_b32 v12, s57, v12
    v_add_f32 v12, v12, v22
    v_cvt_pk_bf16_f32 v12, v12, v12
    s_cmp_lg_u32 s39, 0
    s_cbranch_scc1 L_w_final
    ds_write_b16 v10, v12
    s_waitcnt lgkmcnt(0)
    s_barrier
    s_add_u32 s40, s40, 0xc4000
    s_addc_u32 s41, s41, 0
    s_mov_b32 s39, 1
    s_mov_b32 s43, 30208
    v_and_or_b32 v120, v12, s57, v5
    v_lshlrev_b32 v121, 2, v23
    v_add_u32 v121, 0x1d0000, v121
    s_nop 0
    s_branch L_w_qdone
L_w_next:
    s_add_u32 s40, s40, 0xc4000
    s_addc_u32 s41, s41, 0
    s_mov_b32 s39, 1
    s_mov_b32 s43, 30208
    s_branch L_w_pre
L_w_final:
    v_lshlrev_b32 v11, 1, v23
    s_mov_b32 exec_lo, 0x000f000f
    s_mov_b32 exec_hi, 0x000f000f
    global_store_short v11, v12, s[22:23]
    s_mov_b64 exec, -1
    s_or_b32 s46, s31, s32
    s_cmp_lg_u32 s46, 0
    s_cbranch_scc1 L_end
    v_mov_b32 v5, 0x1e0004
    v_mov_b32 v6, s34
    s_mov_b64 exec, 1
    global_store_dword v5, v6, s[26:27] sc1
    s_mov_b64 exec, -1
    s_branch L_end
L_kv:
    s_setprio 1
    v_and_b32 v5, 7, v0
    v_lshrrev_b32 v6, 3, v0
    v_bfe_u32 v7, v0, 3, 1
    v_bfe_u32 v8, v0, 4, 1
    v_lshl_add_u32 v7, v8, 3, v7
    v_bfe_u32 v8, v0, 5, 1
    v_lshl_add_u32 v7, v8, 1, v7
    s_sub_u32 s56, s32, 8
    s_mul_i32 s46, s30, 3145728
    s_lshl_b32 s47, s31, 8
    s_lshl_b32 s48, s56, 5
    s_add_u32 s47, s47, s48
    s_add_u32 s47, s47, 6144
    s_mul_i32 s47, s47, 384
    s_add_u32 s46, s46, s47
    v_mul_u32_u24 v28, 384, v6
    v_lshl_add_u32 v28, v5, 4, v28
    v_add_u32 v28, s46, v28
    v_add_u32 v29, 6144, v28
    v_mul_u32_u24 v30, 384, v7
    v_lshl_add_u32 v30, v5, 4, v30
    v_add_u32 v30, s46, v30
    v_add_u32 v31, 6144, v30
    s_waitcnt lgkmcnt(0)
    s_barrier
    global_load_dwordx4 v[32:35], v28, s[6:7] offset:0 nt
    global_load_dwordx4 v[36:39], v28, s[6:7] offset:128 nt
    global_load_dwordx4 v[40:43], v28, s[6:7] offset:256 nt
    global_load_dwordx4 v[44:47], v28, s[6:7] offset:3072 nt
    global_load_dwordx4 v[48:51], v28, s[6:7] offset:3200 nt
    s_add_u32 s26, s26, 0x1fffff
    s_addc_u32 s27, s27, 0
    s_and_b32 s26, s26, 0xffe00000
    s_add_u32 s46, s26, 0x1e0004
    s_addc_u32 s47, s27, 0
    s_load_dword s34, s[46:47], 0
    s_mov_b64 s[40:41], s[26:27]
    s_mov_b32 s50, 0xffffff00
    s_mov_b32 s57, 0xffff0000
    s_mov_b32 s52, 0x00ff00ff
    s_mov_b32 s53, 0xff00ff00
    s_mov_b32 s54, 0x00ff00ff
    s_mov_b32 s55, 0x00ff00ff
    s_mov_b32 s39, 0
    s_mov_b32 s42, 0
    s_mov_b32 s3, 0
    s_mov_b32 s43, 13824
    s_cmp_ge_u32 s29, 10
    s_cselect_b32 s36, 1, 0
    s_mul_i32 s48, s36, 10
    s_sub_u32 s37, s29, s48
    s_mov_b32 s35, 0
    s_cmp_lt_u32 s29, 20
    s_cbranch_scc1 L_roledone_64
    s_cmp_ge_u32 s29, 26
    s_cselect_b32 s35, 2, 1
    s_cselect_b32 s48, 26, 20
    s_sub_u32 s48, s29, s48
    s_and_b32 s37, s48, 1
    s_lshr_b32 s48, s48, 1
    s_mul_i32 s36, s28, 3
    s_add_u32 s36, s36, s48
L_roledone_64:
    v_and_b32 v4, 3, v0
    s_mov_b32 s48, 0x55555555
    v_mul_lo_u32 v1, v4, s48
    v_and_b32 v4, 4, v0
    v_cmp_eq_u32 vcc, 0, v4
    v_mov_b32 v4, 0xffff
    s_nop 0
    v_cndmask_b32 v2, 0, v4, vcc
    v_cndmask_b32 v3, v4, 0, vcc
    s_cmp_ge_u32 s56, 6
    s_cselect_b32 s46, 1, 0
    s_mul_i32 s47, s46, 6
    s_sub_u32 s47, s56, s47
    s_lshl_b32 s48, s28, 2
    s_and_b32 s49, s36, 1
    s_lshl_b32 s49, s49, 1
    s_add_u32 s48, s48, s49
    s_add_u32 s48, s48, s46
    s_mul_i32 s44, s48, 7168
    s_lshl_b32 s49, s47, 7
    s_add_u32 s44, s44, s49
    s_add_u32 s44, s44, 0x38000
    s_lshl_b32 s45, s48, 7
    s_add_u32 s45, s45, 0x70000
    s_mul_i32 s51, s46, 192
    s_lshl_b32 s49, s47, 5
    s_add_u32 s51, s51, s49
    s_waitcnt vmcnt(4)
    global_load_dwordx4 v[52:55], v28, s[6:7] offset:3328 nt
    s_waitcnt vmcnt(4)
    global_load_dwordx4 v[56:59], v29, s[6:7] offset:0 nt
    s_waitcnt vmcnt(4)
    global_load_dwordx4 v[60:63], v29, s[6:7] offset:128 nt
    s_waitcnt vmcnt(4)
    global_load_dwordx4 v[64:67], v29, s[6:7] offset:256 nt
    s_waitcnt vmcnt(4)
    global_load_dwordx4 v[68:71], v29, s[6:7] offset:3072 nt
    s_waitcnt vmcnt(4)
    global_load_dwordx4 v[72:75], v29, s[6:7] offset:3200 nt
    s_waitcnt vmcnt(4)
    global_load_dwordx4 v[76:79], v29, s[6:7] offset:3328 nt
    s_waitcnt vmcnt(4)
    global_load_dwordx4 v[80:83], v30, s[8:9] offset:0 nt
    s_waitcnt lgkmcnt(0)
    s_mul_i32 s34, s34, 0x9e3779b1
    s_add_u32 s34, s34, 0x7f4a7c15
    s_and_b32 s33, s34, 0xff
    s_cmp_lg_u32 s32, 15
    s_cbranch_scc1 L_kv_notrig
    v_mov_b32 v5, 13456
    v_mov_b32 v6, s34
    ds_write_b32 v5, v6
    s_nop 0
L_kv_notrig:
    s_waitcnt vmcnt(4)
    global_load_dwordx4 v[84:87], v30, s[8:9] offset:1536 nt
    s_waitcnt vmcnt(4)
    global_load_dwordx4 v[104:107], v31, s[8:9] offset:0 nt
    s_waitcnt vmcnt(4)
    global_load_dwordx4 v[108:111], v31, s[8:9] offset:1536 nt
    s_waitcnt vmcnt(4)
    global_load_dwordx4 v[88:91], v30, s[8:9] offset:128 nt
    s_waitcnt vmcnt(4)
    global_load_dwordx4 v[92:95], v30, s[8:9] offset:1664 nt
    global_load_dwordx4 v[112:115], v31, s[8:9] offset:128 nt
    global_load_dwordx4 v[116:119], v31, s[8:9] offset:1664 nt
    global_load_dwordx4 v[96:99], v30, s[8:9] offset:256 nt
    global_load_dwordx4 v[100:103], v30, s[8:9] offset:1792 nt
    global_load_dwordx4 v[120:123], v31, s[8:9] offset:256 nt
    global_load_dwordx4 v[124:127], v31, s[8:9] offset:1792 nt
L_kv_loop:
    s_sub_u32 s56, s32, 8
    v_and_b32 v7, 7, v0
    v_lshlrev_b32 v4, 5, v7
    v_lshlrev_b32 v7, 4, v7
    v_bfe_u32 v5, v0, 4, 1
    v_lshl_add_u32 v4, v5, 4, v4
    v_lshrrev_b32 v5, 5, v0
    v_lshl_add_u32 v4, v5, 10, v4
    s_lshl_b32 s46, s56, 11
    s_add_u32 s46, s46, s43
    v_add_u32 v4, s46, v4
    v_mov_b32 v20, 0
    v_mov_b32 v21, 0
    v_mov_b32 v22, 0
    v_mov_b32 v23, 0
    v_mov_b32 v8, 0
    v_mov_b32 v9, 0
    v_mov_b32 v10, 0
    v_mov_b32 v11, 0
    v_mov_b32 v12, 0
    v_mov_b32 v13, 0
    v_mov_b32 v14, 0
    v_mov_b32 v15, 0
    v_mov_b32 v16, 0
    v_mov_b32 v17, 0
    v_mov_b32 v18, 0
    v_mov_b32 v19, 0
    s_mov_b32 s48, 0
    s_brev_b32 s49, 1
    s_setprio 2
    s_barrier
    ds_read_b128 v[24:27], v7 offset:12800
    ds_read_b128 v[28:31], v7 offset:12928
    s_waitcnt vmcnt(12)
    s_waitcnt lgkmcnt(1)
    v_dot2c_f32_bf16 v20, v32, v24
    v_dot2c_f32_bf16 v21, v44, v24
    v_dot2c_f32_bf16 v22, v56, v24
    v_dot2c_f32_bf16 v23, v68, v24
    v_dot2c_f32_bf16 v20, v33, v25
    v_dot2c_f32_bf16 v21, v45, v25
    v_dot2c_f32_bf16 v22, v57, v25
    v_dot2c_f32_bf16 v23, v69, v25
    v_dot2c_f32_bf16 v20, v34, v26
    v_dot2c_f32_bf16 v21, v46, v26
    v_dot2c_f32_bf16 v22, v58, v26
    v_dot2c_f32_bf16 v23, v70, v26
    v_dot2c_f32_bf16 v20, v35, v27
    v_dot2c_f32_bf16 v21, v47, v27
    v_dot2c_f32_bf16 v22, v59, v27
    v_dot2c_f32_bf16 v23, v71, v27
    ds_read_b128 v[24:27], v7 offset:13056
    s_waitcnt lgkmcnt(1)
    v_dot2c_f32_bf16 v20, v36, v28
    v_dot2c_f32_bf16 v21, v48, v28
    v_dot2c_f32_bf16 v22, v60, v28
    v_dot2c_f32_bf16 v23, v72, v28
    v_dot2c_f32_bf16 v20, v37, v29
    v_dot2c_f32_bf16 v21, v49, v29
    v_dot2c_f32_bf16 v22, v61, v29
    v_dot2c_f32_bf16 v23, v73, v29
    v_dot2c_f32_bf16 v20, v38, v30
    v_dot2c_f32_bf16 v21, v50, v30
    v_dot2c_f32_bf16 v22, v62, v30
    v_dot2c_f32_bf16 v23, v74, v30
    v_dot2c_f32_bf16 v20, v39, v31
    v_dot2c_f32_bf16 v21, v51, v31
    v_dot2c_f32_bf16 v22, v63, v31
    v_dot2c_f32_bf16 v23, v75, v31
    s_waitcnt lgkmcnt(0)
    v_dot2c_f32_bf16 v20, v40, v24
    v_dot2c_f32_bf16 v21, v52, v24
    v_dot2c_f32_bf16 v22, v64, v24
    v_dot2c_f32_bf16 v23, v76, v24
    v_dot2c_f32_bf16 v20, v41, v25
    v_dot2c_f32_bf16 v21, v53, v25
    v_dot2c_f32_bf16 v22, v65, v25
    v_dot2c_f32_bf16 v23, v77, v25
    v_dot2c_f32_bf16 v20, v42, v26
    v_dot2c_f32_bf16 v21, v54, v26
    v_dot2c_f32_bf16 v22, v66, v26
    v_dot2c_f32_bf16 v23, v78, v26
    v_dot2c_f32_bf16 v20, v43, v27
    v_dot2c_f32_bf16 v21, v55, v27
    v_dot2c_f32_bf16 v22, v67, v27
    v_dot2c_f32_bf16 v23, v79, v27
    s_setprio 1
    v_add_f32_dpp v24, v20, v20 row_half_mirror row_mask:0xf bank_mask:0x5
    v_add_f32_dpp v25, v21, v21 row_half_mirror row_mask:0xf bank_mask:0x5
    s_nop 0
    v_add_f32_dpp v24, v22, v22 row_half_mirror row_mask:0xf bank_mask:0xa
    v_add_f32_dpp v25, v23, v23 row_half_mirror row_mask:0xf bank_mask:0xa
    s_nop 0
    v_add_f32_dpp v24, v24, v24 quad_perm:[1,0,3,2] row_mask:0xf bank_mask:0xf
    v_add_f32_dpp v25, v25, v25 quad_perm:[1,0,3,2] row_mask:0xf bank_mask:0xf
    s_nop 0
    v_add_f32_dpp v24, v24, v24 quad_perm:[2,3,0,1] row_mask:0xf bank_mask:0xf
    v_add_f32_dpp v25, v25, v25 quad_perm:[2,3,0,1] row_mask:0xf bank_mask:0xf
    v_max_f32 v5, v24, v25
    s_nop 1
    v_max_f32_dpp v5, v5, v5 row_half_mirror row_mask:0xf bank_mask:0xf
    s_nop 1
    v_max_f32_dpp v5, v5, v5 row_ror:8 row_mask:0xf bank_mask:0xf
    s_nop 1
    v_max_f32_dpp v5, v5, v5 row_bcast:15 row_mask:0xa bank_mask:0xf
    s_nop 1
    v_max_f32_dpp v5, v5, v5 row_bcast:31 row_mask:0xc bank_mask:0xf
    s_nop 0
    v_readlane_b32 s46, v5, 63
    s_mov_b64 exec, s[48:49]
    ds_write_b32 v4, v5 offset:528
    s_mov_b64 exec, -1
    v_subrev_f32 v20, s46, v24
    v_subrev_f32 v21, s46, v25
    v_exp_f32 v20, v20
    v_exp_f32 v21, v21
    s_nop 0
    v_cvt_pk_bf16_f32 v22, v20, v21
    v_add_f32 v6, v20, v21
    v_and_b32 v24, v22, v2
    v_mov_b32_dpp v23, v22 row_half_mirror row_mask:0xf bank_mask:0xf
    v_and_b32_sdwa v26, v22, v2 dst_sel:DWORD dst_unused:UNUSED_PAD src0_sel:WORD_1 src1_sel:DWORD
    v_and_b32 v25, v23, v3
    v_and_b32_sdwa v27, v23, v3 dst_sel:DWORD dst_unused:UNUSED_PAD src0_sel:WORD_1 src1_sel:DWORD
    v_and_b32 v28, v23, v2
    v_and_b32 v29, v22, v3
    s_waitcnt vmcnt(10)
    v_smfmac_f32_16x16x64_bf16 v[8:11], v[24:27], v[80:87], v1
    v_and_b32_sdwa v30, v23, v2 dst_sel:DWORD dst_unused:UNUSED_PAD src0_sel:WORD_1 src1_sel:DWORD
    v_and_b32_sdwa v31, v22, v3 dst_sel:DWORD dst_unused:UNUSED_PAD src0_sel:WORD_1 src1_sel:DWORD
    v_add_f32_dpp v6, v6, v6 row_half_mirror row_mask:0xf bank_mask:0xf
    s_waitcnt vmcnt(8)
    v_smfmac_f32_16x16x64_bf16 v[8:11], v[28:31], v[104:111], v1
    v_add_f32_dpp v6, v6, v6 row_ror:8 row_mask:0xf bank_mask:0xf
    s_waitcnt vmcnt(6)
    v_smfmac_f32_16x16x64_bf16 v[12:15], v[24:27], v[88:95], v1
    v_add_f32_dpp v6, v6, v6 row_bcast:15 row_mask:0xa bank_mask:0xf
    s_waitcnt vmcnt(4)
    v_smfmac_f32_16x16x64_bf16 v[12:15], v[28:31], v[112:119], v1
    v_add_f32_dpp v6, v6, v6 row_bcast:31 row_mask:0xc bank_mask:0xf
    s_waitcnt vmcnt(2)
    v_smfmac_f32_16x16x64_bf16 v[16:19], v[24:27], v[96:103], v1
    s_mov_b64 exec, s[52:53]
    ds_write_b128 v4, v[8:11] offset:0
    s_mov_b64 exec, -1
    s_waitcnt vmcnt(0)
    v_smfmac_f32_16x16x64_bf16 v[16:19], v[28:31], v[120:127], v1
    s_mov_b64 exec, s[48:49]
    ds_write_b32 v4, v6 offset:532
    s_mov_b64 exec, s[52:53]
    ds_write_b128 v4, v[12:15] offset:256
    s_nop 3
    ds_write_b128 v4, v[16:19] offset:512
    s_mov_b64 exec, -1
    s_waitcnt lgkmcnt(0)
    s_barrier
    s_cmp_eq_u32 s35, 1
    s_cbranch_scc1 L_kv_r1
    s_cmp_eq_u32 s35, 2
    s_cbranch_scc1 L_kv_r2
    v_and_b32 v24, 7, v0
    v_lshrrev_b32 v25, 3, v0
    v_lshl_add_u32 v9, v24, 4, s45
    v_lshl_add_u32 v10, v25, 4, s45
    global_load_dwordx2 v[18:19], v9, s[40:41] sc1
    global_load_dwordx2 v[20:21], v10, s[40:41] sc1
    v_mul_u32_u24 v8, 896, v25
    v_lshl_add_u32 v8, v24, 4, v8
    v_add_u32 v8, s44, v8
    v_mov_b32 v5, s33
    v_lshrrev_b32 v25, 4, v0
    v_lshl_add_u32 v25, v24, 2, v25
    v_add_u32 v25, s51, v25
    v_and_b32 v27, 7, v25
    v_mul_u32_u24 v11, 400, v27
    v_and_b32 v27, 0xfffffff8, v25
    v_add_u32 v11, v11, v27
    v_and_b32 v27, 8, v0
    v_lshrrev_b32 v27, 3, v27
    v_mul_u32_u24 v27, 3204, v27
    v_add_u32 v11, v11, v27
    v_add_u32 v11, 6400, v11
    s_mov_b32 s38, 0
    s_branch L_h1mw_66
L_h1m_65:
    global_load_dwordx2 v[18:19], v9, s[40:41] sc1
    global_load_dwordx2 v[20:21], v10, s[40:41] sc1
L_h1mw_66:
    s_waitcnt vmcnt(0)
    v_bitop3_b32 v24, v19, v21, s34 bitop3:0x7e
    v_cmp_ne_u32 vcc, 0, v24
    s_nop 0
    s_cbranch_vccnz L_retry_69
    global_load_dwordx2 v[16:17], v9, s[40:41] offset:8 sc1
    global_load_dwordx4 v[12:15], v8, s[40:41] sc1
    v_mov_b32 v27, v18
    s_nop 1
    v_max_f32_dpp v27, v27, v27 quad_perm:[1,0,3,2] row_mask:0xf bank_mask:0xf
    s_nop 1
    v_max_f32_dpp v27, v27, v27 quad_perm:[2,3,0,1] row_mask:0xf bank_mask:0xf
    s_nop 1
    v_max_f32_dpp v27, v27, v27 row_half_mirror row_mask:0xf bank_mask:0xf
    v_sub_f32 v18, v18, v27
    v_sub_f32 v20, v20, v27
    v_exp_f32 v4, v18
    v_exp_f32 v10, v20
    s_nop 0
    s_branch L_h1dw_68
L_h1d_67:
    global_load_dwordx2 v[16:17], v9, s[40:41] offset:8 sc1
    global_load_dwordx4 v[12:15], v8, s[40:41] sc1
L_h1dw_68:
    s_waitcnt vmcnt(0)
    v_xor_b32 v13, v5, v13
    v_xor_b32 v15, v5, v15
    v_or_b32 v24, v13, v15
    v_bitop3_b32 v25, v17, v17, s34 bitop3:0x7e
    v_or_b32_sdwa v24, v24, v25 dst_sel:DWORD dst_unused:UNUSED_PAD src0_sel:BYTE_0 src1_sel:DWORD
    v_cmp_ne_u32 vcc, 0, v24
    v_mul_f32 v28, v12, v10
    v_mul_f32 v29, v13, v10
    v_mul_f32 v30, v14, v10
    v_mul_f32 v31, v15, v10
    v_mul_f32 v27, v16, v4
    s_nop 0
    s_cbranch_vccnz L_retry_70
    v_permlane32_swap_b32 v28, v30
    v_permlane32_swap_b32 v29, v31
    v_add_f32_dpp v27, v27, v27 quad_perm:[1,0,3,2] row_mask:0xf bank_mask:0xf
    v_add_f32 v28, v28, v30
    v_add_f32 v29, v29, v31
    v_add_f32_dpp v27, v27, v27 quad_perm:[2,3,0,1] row_mask:0xf bank_mask:0xf
    s_nop 0
    v_permlane16_swap_b32 v28, v29
    v_add_f32 v28, v28, v29
    v_add_f32_dpp v27, v27, v27 row_half_mirror row_mask:0xf bank_mask:0xf
    v_rcp_f32 v27, v27
    v_add_f32_dpp v28, v28, v28 row_ror:8 row_mask:0xf bank_mask:0xf
    v_mul_f32 v28, v28, v27
    v_cvt_pk_bf16_f32 v28, v28, v28
    ds_write_b16 v11, v28
    s_waitcnt lgkmcnt(0)
    s_barrier
    s_waitcnt vmcnt(0)
    s_barrier
    s_branch L_kv_roledone
L_kv_r1:
    v_mov_b32 v5, 13444
    ds_read_b32 v5, v5
    s_waitcnt lgkmcnt(0)
    v_readfirstlane_b32 s42, v5
    s_cmp_lg_u32 s39, 0
    s_nop 2
    s_cbranch_scc1 L_nv_71
    s_lshl_b32 s46, s28, 8
    s_add_u32 s46, s46, 0x1d8800
    v_and_b32 v5, 31, v0
    v_lshl_add_u32 v5, v5, 3, s46
    global_load_dwordx2 v[6:7], v5, s[26:27] sc1
    s_waitcnt vmcnt(0)
    v_cmp_eq_u32 s[48:49], s34, v7
    v_cmp_ne_u32 vcc, 0, v6
    s_nop 0
    s_and_b64 vcc, vcc, s[48:49]
    s_bcnt1_i32_b64 s46, vcc
    s_bcnt1_i32_b64 s47, s[48:49]
    s_lshl_b32 s46, s46, 1
    s_cmp_gt_u32 s46, s47
    s_cselect_b32 s3, 0x2000, 0
L_nv_71:
    v_mov_b32 v5, s33
    v_and_b32 v24, 7, v0
    v_lshrrev_b32 v25, 3, v0
    s_mul_i32 s46, s37, 1280
    s_lshl_b32 s47, s56, 7
    s_add_u32 s46, s46, s47
    s_add_u32 s48, s46, 0x84000
    s_add_u32 s48, s48, s3
    v_lshlrev_b32 v8, 14, v25
    v_lshl_add_u32 v8, v24, 4, v8
    v_add_u32 v8, s48, v8
    v_add_u32 v9, 2688, v8
    v_lshrrev_b32 v25, 4, v0
    v_lshl_add_u32 v25, v24, 2, v25
    s_lshl_b32 s47, s56, 5
    v_add_u32 v25, s47, v25
    v_and_b32 v27, 7, v25
    v_mul_u32_u24 v10, 400, v27
    v_and_b32 v27, 0xfffffff8, v25
    v_add_u32 v10, v10, v27
    v_and_b32 v27, 8, v0
    v_lshrrev_b32 v27, 3, v27
    v_mul_u32_u24 v27, 3204, v27
    v_add_u32 v10, v10, v27
    v_add_u32 v10, 6400, v10
    s_mul_i32 s47, s37, 320
    v_add_u32 v25, s47, v25
    s_cmp_lg_u32 s39, 0
    s_cbranch_scc1 L_h2k1_72
    v_lshlrev_b32 v11, 1, v25
    global_load_ushort v22, v11, s[4:5]
    s_waitcnt vmcnt(0)
    v_lshlrev_b32 v22, 16, v22
    s_nop 0
    s_branch L_h2j_73
L_h2k1_72:
    v_lshlrev_b32 v11, 2, v25
    v_add_u32 v11, 0x1d0000, v11
    s_mov_b32 s38, 0
    s_nop 0
L_poll_74:
    global_load_dword v22, v11, s[26:27] sc1
    s_waitcnt vmcnt(0)
    v_xor_b32 v22, v5, v22
    v_cmp_ne_u32_sdwa vcc, v22, 0 src0_sel:BYTE_0 src1_sel:DWORD
    s_nop 0
    s_cbranch_vccnz L_retry_76
    v_and_b32 v22, s57, v22
    s_nop 1
L_h2j_73:
    v_lshlrev_b32 v11, 2, v25
    v_add_u32 v11, 0x85500, v11
    s_barrier
    s_mov_b32 s38, 0
L_poll_77:
    global_load_dwordx4 v[12:15], v8, s[40:41] sc1
    global_load_dwordx4 v[16:19], v9, s[40:41] sc1
    s_waitcnt vmcnt(0)
    v_xor_b32 v13, v5, v13
    v_xor_b32 v15, v5, v15
    v_xor_b32 v17, v5, v17
    v_xor_b32 v19, v5, v19
    v_or3_b32 v24, v13, v15, v17
    v_or_b32 v24, v24, v19
    v_cmp_ne_u32_sdwa vcc, v24, 0 src0_sel:BYTE_0 src1_sel:DWORD
    s_nop 0
    s_cbranch_vccnz L_retry_79
    v_add_f32 v12, v12, v16
    v_add_f32 v13, v13, v17
    v_add_f32 v14, v14, v18
    v_add_f32 v15, v15, v19
    s_nop 0
    v_permlane32_swap_b32 v12, v14
    v_permlane32_swap_b32 v13, v15
    v_add_f32 v12, v12, v14
    v_add_f32 v13, v13, v15
    s_nop 1
    v_permlane16_swap_b32 v12, v13
    v_add_f32 v12, v12, v13
    s_nop 1
    v_add_f32_dpp v12, v12, v12 row_ror:8 row_mask:0xf bank_mask:0xf
    v_cvt_pk_bf16_f32 v12, v12, v12
    v_and_b32 v12, s57, v12
    v_add_f32 v12, v12, v22
    v_cvt_pk_bf16_f32 v12, v12, v12
    ds_write_b16 v10, v12
    s_cmp_lg_u32 s36, 0
    s_cbranch_scc1 L_h2s_80
    v_and_or_b32 v12, v12, s57, v5
    s_mov_b64 exec, s[54:55]
    global_store_dword v11, v12, s[40:41] sc1
    v_add_u32 v11, 0x2000, v11
    global_store_dword v11, v12, s[40:41] sc1
    s_mov_b64 exec, -1
L_h2s_80:
    s_waitcnt lgkmcnt(0)
L_kv_r2:
    s_barrier
L_kv_roledone:
    s_cmp_lg_u32 s39, 0
    s_cbranch_scc1 L_end
    s_add_u32 s40, s40, 0xc4000
    s_addc_u32 s41, s41, 0
    s_mov_b32 s39, 1
    s_mov_b32 s43, 30208
    s_cmp_lg_u32 s32, 8
    s_cbranch_scc1 L_kv_nost
    v_mov_b32 v5, 13444
    ds_read_b32 v5, v5
    s_waitcnt lgkmcnt(0)
    v_readfirstlane_b32 s42, v5
    v_and_b32 v8, 7, v0
    v_lshrrev_b32 v5, 3, v0
    v_mul_u32_u24 v5, 400, v5
    v_lshl_add_u32 v5, v8, 3, v5
    s_lshl_b32 s46, s30, 3
    s_add_u32 s46, s46, s31
    s_lshl_b32 s46, s46, 4
    s_add_u32 s46, s46, 466944
    v_lshrrev_b32 v8, 5, v0
    v_lshl_add_u32 v4, v8, 3, s46
    v_mov_b32 v9, s33
    v_mov_b32 v10, 0
    v_mov_b32 v11, 0
    v_mov_b32 v17, s34
    s_setprio 3
    s_barrier
    s_barrier
    ds_read_u16_d16_hi v10, v5 offset:0
    ds_read_u16_d16_hi v11, v5 offset:64
    s_waitcnt lgkmcnt(0)
    v_mul_f32 v7, v10, v10
    v_add_f32 v16, v10, v11
    v_fmac_f32 v7, v11, v11
    s_nop 1
    v_permlane32_swap_b32 v16, v7
    v_add_f32 v16, v16, v7
    s_nop 1
    v_add_f32_dpp v16, v16, v16 quad_perm:[1,0,3,2] row_mask:0xf bank_mask:0xf
    s_nop 1
    v_add_f32_dpp v16, v16, v16 quad_perm:[2,3,0,1] row_mask:0xf bank_mask:0xf
    s_nop 1
    v_add_f32_dpp v16, v16, v16 row_half_mirror row_mask:0xf bank_mask:0xf
    s_nop 1
    v_add_f32_dpp v16, v16, v16 row_ror:8 row_mask:0xf bank_mask:0xf
    s_nop 1
    v_add_f32_dpp v16, v16, v16 row_bcast:15 row_mask:0xa bank_mask:0xf
    s_mov_b32 exec_lo, 0x10000
    s_mov_b32 exec_hi, 0x10000
    s_cmp_eq_u32 s42, 0
    s_cbranch_scc1 L_slow_81
    global_store_dwordx2 v4, v[16:17], s[40:41]
L_back_82:
    s_mov_b64 exec, -1
    s_setprio 1
    s_branch L_kv_loop
L_kv_nost:
    s_barrier
    s_barrier
    s_branch L_kv_loop
L_retry_6:
    s_sleep 8
    s_add_u32 s38, s38, 1
    s_cmp_lt_u32 s38, 2097152
    s_cbranch_scc1 L_poll_4
    s_branch L_end
L_retry_10:
    s_add_u32 s38, s38, 1
    s_cmp_lt_u32 s38, 2097152
    s_cbranch_scc1 L_pp_7
    s_branch L_end
L_retry_22:
    s_sleep 2
    s_add_u32 s38, s38, 1
    s_cmp_lt_u32 s38, 2097152
    s_cbranch_scc1 L_poll_20
    s_branch L_end
L_retry_27:
    s_add_u32 s38, s38, 1
    s_cmp_lt_u32 s38, 2097152
    s_cbranch_scc1 L_h1m_23
    s_branch L_end
L_retry_28:
    s_add_u32 s38, s38, 1
    s_cmp_lt_u32 s38, 2097152
    s_cbranch_scc1 L_h1d_25
    s_branch L_end
L_retry_34:
    s_add_u32 s38, s38, 1
    s_cmp_lt_u32 s38, 2097152
    s_cbranch_scc1 L_poll_32
    s_branch L_end
L_retry_37:
    s_add_u32 s38, s38, 1
    s_cmp_lt_u32 s38, 2097152
    s_cbranch_scc1 L_poll_35
    s_branch L_end
L_retry_41:
    s_add_u32 s38, s38, 1
    s_cmp_lt_u32 s38, 2097152
    s_cbranch_scc1 L_sent_39
    s_branch L_end
L_retry_50:
    s_sleep 2
    s_add_u32 s38, s38, 1
    s_cmp_lt_u32 s38, 2097152
    s_cbranch_scc1 L_poll_48
    s_branch L_end
L_retry_53:
    s_add_u32 s38, s38, 1
    s_cmp_lt_u32 s38, 2097152
    s_cbranch_scc1 L_poll_51
    s_branch L_end
L_retry_57:
    s_sleep 2
    s_add_u32 s38, s38, 1
    s_cmp_lt_u32 s38, 2097152
    s_cbranch_scc1 L_poll_55
    s_branch L_end
L_retry_60:
    s_add_u32 s38, s38, 1
    s_cmp_lt_u32 s38, 2097152
    s_cbranch_scc1 L_sent_58
    s_branch L_end
L_retry_63:
    s_add_u32 s38, s38, 1
    s_cmp_lt_u32 s38, 2097152
    s_cbranch_scc1 L_poll_61
    s_branch L_end
L_retry_69:
    s_add_u32 s38, s38, 1
    s_cmp_lt_u32 s38, 2097152
    s_cbranch_scc1 L_h1m_65
    s_branch L_end
L_retry_70:
    s_add_u32 s38, s38, 1
    s_cmp_lt_u32 s38, 2097152
    s_cbranch_scc1 L_h1d_67
    s_branch L_end
L_retry_76:
    s_add_u32 s38, s38, 1
    s_cmp_lt_u32 s38, 2097152
    s_cbranch_scc1 L_poll_74
    s_branch L_end
L_retry_79:
    s_add_u32 s38, s38, 1
    s_cmp_lt_u32 s38, 2097152
    s_cbranch_scc1 L_poll_77
    s_branch L_end
L_slow_2:
    global_store_dwordx2 v6, v[12:13], s[40:41] sc1
    s_branch L_back_3
L_slow_11:
    global_store_dwordx2 v121, v[12:13], s[26:27] sc1
    s_branch L_back_12
L_slow_13:
    global_store_dwordx2 v7, v[12:13], s[40:41] sc1
    s_branch L_back_14
L_slow_15:
    global_store_dwordx2 v8, v[10:11], s[40:41] sc1
    s_branch L_back_16
L_slow_17:
    global_store_dwordx2 v8, v[14:15], s[40:41] offset:8 sc1
    s_branch L_back_18
L_slow_42:
    global_store_dwordx2 v4, v[16:17], s[40:41] sc1
    s_branch L_back_43
L_slow_44:
    global_store_dwordx2 v14, v[12:13], s[26:27] sc1
    s_branch L_back_45
L_slow_46:
    global_store_dwordx2 v7, v[12:13], s[40:41] sc1
    s_branch L_back_47
L_slow_81:
    global_store_dwordx2 v4, v[16:17], s[40:41] sc1
    s_branch L_back_82
L_end:
    s_mov_b64 exec, -1
L_exit:
    s_endpgm
.section .rodata,"a"
.p2align 6
.amdhsa_kernel interleave_layers__sliding_block_cached__dense_activation_mish__decode_kernel
  .amdhsa_next_free_vgpr 128
  .amdhsa_next_free_sgpr 102
  .amdhsa_accum_offset 128
  .amdhsa_group_segment_fixed_size 0
  .amdhsa_kernarg_size 96
  .amdhsa_user_sgpr_count 2
  .amdhsa_user_sgpr_kernarg_segment_ptr 1
  .amdhsa_system_sgpr_workgroup_id_x 1
.end_amdhsa_kernel
```
